```python
import torch

def _softmax(x, axis=-1):
    return torch.softmax(x, dim=axis)
def _gelu(x):
    return torch.nn.functional.gelu(x, approximate="tanh")
def _silu(x):
    return torch.nn.functional.silu(x)
def _sigmoid(x):
    return torch.sigmoid(x)
def _layernorm(x, axis=-1, eps=1e-5):
    m = x.mean(dim=axis, keepdim=True)
    v = x.var(dim=axis, keepdim=True, unbiased=False)
    return (x - m) / torch.sqrt(v + eps)
def _scatter_add(tgt, idx, src, axis=0):
    return tgt.clone().index_add_(axis, idx, src)
def _segment_sum(src, seg, n):
    out = torch.zeros((n,) + src.shape[1:], dtype=src.dtype)
    return out.index_add_(0, seg, src)
def _pad(x, pw):
    flat = tuple(v for pair in reversed(pw) for v in pair)
    return torch.nn.functional.pad(x, flat)

kernel_name = 'sequential_preLN__mha_block__moe_arch_mod__prompt'

def setup_inputs():

    _w = (lambda a: (lambda t: t.to(torch.bfloat16) if t.is_floating_point() else t)(torch.as_tensor(a)))
    def _A_setup():
        B, S, D, H = 1, 2048, 640, 32
        return {
            "x": _w((lambda *s: torch.randn(*s, dtype=torch.bfloat16) * 0.05)(B, S, D)),
            "wqkv": _w((lambda *s: torch.randn(*s, dtype=torch.bfloat16) * 0.05)(D, 3 * D)),
            "wo": _w((lambda *s: torch.randn(*s, dtype=torch.bfloat16) * 0.05)(D, D)),
        }
    _A_in = _A_setup()

    def _B_setup():
        B, S, D, F, C = 1, 2048, 640, 1728, 1
        return {
            "x": _w((lambda *s: torch.randn(*s, dtype=torch.bfloat16) * 0.05)(B, S, D)),
            "w_r": _w((lambda *s: torch.randn(*s, dtype=torch.bfloat16) * 0.05)(D)),
            "w_gate": _w((lambda *s: torch.randn(*s, dtype=torch.bfloat16) * 0.05)(D, F)),
            "w_up": _w((lambda *s: torch.randn(*s, dtype=torch.bfloat16) * 0.05)(D, F)),
            "w_down": _w((lambda *s: torch.randn(*s, dtype=torch.bfloat16) * 0.05)(F, D)),
        }
    _B_in = _B_setup()

    return {
        "A_x": _A_in["x"],
        "A_wqkv": _A_in["wqkv"],
        "A_wo": _A_in["wo"],
        "B_x": _B_in["x"],
        "B_w_r": _B_in["w_r"],
        "B_w_gate": _B_in["w_gate"],
        "B_w_up": _B_in["w_up"],
        "B_w_down": _B_in["w_down"],
    }

def reference(A_x, A_wqkv, A_wo, B_x, B_w_r, B_w_gate, B_w_up, B_w_down):
    def _A_ref(x, wqkv, wo):
        B, S, D = x.shape
        H = 32
        Dh = D // H
        qkv = (lambda x, *d: x.permute(*d))((x @ wqkv).reshape(B, S, 3, H, Dh), 2, 0, 3, 1, 4)
        q, k, v = qkv[0], qkv[1], qkv[2]
        scores = torch.einsum("bhqd,bhkd->bhqk", q, k) * (Dh ** -0.5)
        p = _softmax(scores, axis=-1)
        o = torch.einsum("bhqk,bhkd->bhqd", p, v)
        return (lambda x, *d: x.permute(*d))(o, 0, 2, 1, 3).reshape(B, S, D) @ wo

    def _B_ref(x, w_r, w_gate, w_up, w_down):
        B, S, D = x.shape
        C = 1
        r = x @ w_r
        idx = torch.argsort(-r, axis=-1)[:, :C]
        idx_e = (lambda x, n, axis: torch.repeat_interleave(x, n, dim=axis))(idx.reshape(B, C, 1), D, axis=2)
        x_sel = (lambda x, i, axis: torch.take_along_dim(x, i, dim=axis))(x, idx_e, axis=1)
        g = _silu(x_sel @ w_gate)
        u = x_sel @ w_up
        y = (g * u) @ w_down
        r_sel = _sigmoid((lambda x, i, axis: torch.take_along_dim(x, i, dim=axis))(r, idx, axis=1))
        y = y * r_sel.reshape(B, C, 1)
        b_off = (torch.arange(B) * S).reshape(B, 1)
        flat_idx = (idx + b_off).reshape(B * C)
        zero = (x * 0.0).reshape(B * S, D)
        upd = _scatter_add(zero, flat_idx, y.reshape(B * C, D), axis=0)
        return x + upd.reshape(B, S, D)

    x = A_x
    h = x + _A_ref(_layernorm(x, axis=-1), A_wqkv, A_wo)
    h2 = h + _B_ref(_layernorm(h, axis=-1), B_w_r, B_w_gate, B_w_up, B_w_down)
    return h2
```

```asm
; @launch kernel=sequential_preLN__mha_block__moe_arch_mod__prompt_kernel grid=(256,1,1) block=(512,1,1) lds=163840
.amdgcn_target "amdgcn-amd-amdhsa--gfx950"
.text
.globl sequential_preLN__mha_block__moe_arch_mod__prompt_kernel
.p2align 8
.type sequential_preLN__mha_block__moe_arch_mod__prompt_kernel,@function
sequential_preLN__mha_block__moe_arch_mod__prompt_kernel:
  s_cmp_ge_u32 s2, 256
  s_cbranch_scc1 sequential_preLN__mha_block__moe_arch_mod__prompt_kernel_end1
  s_load_dwordx4 s[60:63], s[0:1], 0
  s_load_dwordx4 s[56:59], s[0:1], 72
  v_mov_b32 v159, v0
  v_lshrrev_b32 v1, 6, v0
  v_and_b32 v155, 63, v0
  v_readfirstlane_b32 s26, v1
  s_and_b32 s3, s2, 7
  s_mul_i32 s10, s3, 30
  s_lshr_b32 s11, s2, 3
  s_add_u32 s10, s10, s11
  s_mul_i32 s11, s10, 1093
  s_lshr_b32 s11, s11, 16
  s_mul_i32 s29, s11, 60
  s_sub_u32 s10, s10, s29
  s_lshr_b32 s33, s10, 2
  s_and_b32 s10, s10, 3
  s_lshl_b32 s29, s11, 2
  s_add_u32 s29, s29, s10
  s_add_u32 s34, s29, s33
  s_mul_i32 s35, s34, 26
  s_lshr_b32 s35, s35, 8
  s_mul_i32 s35, s35, 10
  s_sub_u32 s34, s34, s35
  s_and_b32 s27, s26, 1
  s_lshr_b32 s28, s26, 1
  s_mul_i32 s30, s28, 20480
  s_lshl_b32 s31, s27, 10
  s_add_u32 s30, s30, s31
  s_lshl_b32 s31, s26, 10
  s_add_u32 s31, s31, 81920
  s_mul_i32 s36, s29, 163840
  s_lshl_b32 s37, s33, 8
  v_lshrrev_b32 v1, 3, v155
  s_lshl_b32 s10, s27, 3
  v_add_u32 v4, s10, v1
  v_bfe_u32 v2, v4, 1, 3
  v_and_b32 v3, 7, v155
  v_xor_b32 v2, v2, v3
  s_lshl_b32 s10, s28, 5
  v_add_u32 v4, s10, v4
  v_mul_u32_u24 v4, 1280, v4
  v_lshl_add_u32 v110, v2, 4, v4
  v_add_u32 v111, 20480, v110
  s_lshl_b32 s10, s26, 3
  v_add_u32 v1, s10, v1
  v_mul_u32_u24 v1, 3840, v1
  v_bfe_u32 v2, v155, 4, 1
  s_lshl_b32 s10, s27, 1
  v_or_b32 v2, s10, v2
  v_lshlrev_b32 v2, 1, v2
  v_xor_b32 v2, v2, v3
  v_lshl_add_u32 v112, v2, 4, v1
  s_waitcnt lgkmcnt(0)
  s_mov_b32 s68, s62
  s_mov_b32 s69, s63
  s_mov_b32 s20, s58
  s_mov_b32 s21, s59
  s_mov_b32 s62, 2621440
  s_mov_b32 s63, 0x20000
  s_mov_b32 s70, 2457600
  s_mov_b32 s71, 0x20000
  s_cmp_ge_u32 s2, 240
  s_cbranch_scc1 sequential_preLN__mha_block__moe_arch_mod__prompt_kernel_nd3
  s_lshl_b32 s32, s34, 7
  s_add_u32 s32, s32, s36
  s_mul_i32 s35, s34, 245760
  s_add_u32 s35, s35, s37
  s_add_u32 m0, s30, 0
  s_add_u32 s34, s34, 1
  buffer_load_dwordx4 v110, s[60:63], s32 offen lds
  s_add_u32 m0, s31, 0
  s_cmp_eq_u32 s34, 10
  buffer_load_dwordx4 v112, s[68:71], s35 offen lds
  s_cselect_b32 s34, 0, s34
  s_add_u32 m0, s30, 2048
  s_nop 0
  buffer_load_dwordx4 v111, s[60:63], s32 offen lds
  s_add_u32 m0, s31, 40832
  s_nop 0
  buffer_load_dwordx4 v112, s[68:71], s35 offen offset:128 lds
  s_lshl_b32 s32, s34, 7
  s_add_u32 s32, s32, s36
  s_mul_i32 s35, s34, 245760
  s_add_u32 s35, s35, s37
  s_add_u32 m0, s30, 4096
  s_add_u32 s34, s34, 1
  buffer_load_dwordx4 v110, s[60:63], s32 offen lds
  s_add_u32 m0, s31, 8192
  s_cmp_eq_u32 s34, 10
  buffer_load_dwordx4 v112, s[68:71], s35 offen lds
  s_cselect_b32 s34, 0, s34
  s_add_u32 m0, s30, 6144
  s_nop 0
  buffer_load_dwordx4 v111, s[60:63], s32 offen lds
  s_add_u32 m0, s31, 49024
  s_nop 0
  buffer_load_dwordx4 v112, s[68:71], s35 offen offset:128 lds
sequential_preLN__mha_block__moe_arch_mod__prompt_kernel_nd3:
  s_load_dwordx2 s[12:13], s[0:1], 16
  s_load_dwordx2 s[64:65], s[0:1], 32
  s_load_dwordx2 s[16:17], s[0:1], 40
  s_load_dwordx2 s[44:45], s[0:1], 48
  s_load_dwordx2 s[4:5], s[0:1], 56
  s_load_dwordx2 s[48:49], s[0:1], 64
  s_mov_b32 s22, 268435456
  s_mov_b32 s23, 0x20000
  s_mov_b32 s58, 256
  s_mov_b32 s59, 0x20000
  v_lshlrev_b32 v196, 4, v159
  v_mov_b32 v192, -1
  v_mov_b32 v193, -1
  v_mov_b32 v194, -1
  v_mov_b32 v195, -1
  s_cmp_ge_u32 s2, 240
  s_cbranch_scc0 sequential_preLN__mha_block__moe_arch_mod__prompt_kernel_nf4
  s_lshl_b32 s11, s2, 11
  s_add_u32 s11, s11, 16220160
  v_min_u32 v13, 2032, v196
  buffer_store_dwordx4 v[192:195], v13, s[20:23], s11 offen sc1
sequential_preLN__mha_block__moe_arch_mod__prompt_kernel_nf4:
  v_lshlrev_b32 v158, 4, v155
  v_mov_b32 v8, 0x3f803f80
  v_and_b32 v156, 31, v155
  v_lshrrev_b32 v157, 5, v155
  v_and_b32 v1, 15, v155
  v_lshrrev_b32 v2, 4, v155
  v_bfe_u32 v3, v155, 1, 3
  v_xor_b32 v3, v3, v2
  v_lshlrev_b32 v3, 4, v3
  v_lshl_add_u32 v3, v1, 7, v3
  s_mul_i32 s10, s28, 20480
  s_lshl_b32 s11, s27, 11
  s_add_u32 s10, s10, s11
  v_add_u32 v104, s10, v3
  v_xor_b32 v105, 2048, v104
  v_xor_b32 v136, 64, v104
  v_xor_b32 v137, 64, v105
  v_bfe_u32 v3, v155, 2, 2
  v_lshl_add_u32 v4, v2, 3, v3
  v_lshlrev_b32 v4, 7, v4
  v_bfe_u32 v5, v155, 3, 1
  v_bfe_u32 v6, v155, 4, 1
  v_lshl_add_u32 v5, v6, 1, v5
  v_lshl_add_u32 v4, v5, 5, v4
  v_and_b32 v5, 3, v155
  v_lshl_add_u32 v4, v5, 3, v4
  s_mul_i32 s10, s27, 40960
  s_add_u32 s10, s10, 81920
  v_add_u32 v106, s10, v4
  v_xor_b32 v107, 32, v106
  v_xor_b32 v108, 64, v106
  v_xor_b32 v109, 96, v106
  v_cmp_eq_u32 s[50:51], 0, v1
  v_cmp_eq_u32 s[52:53], 1, v1
  v_cmp_eq_u32 s[54:55], 2, v1
  v_cmp_eq_u32 vcc, 3, v1
  v_mov_b32 v36, 0
  v_mov_b32 v37, 0
  v_mov_b32 v38, 0
  v_mov_b32 v39, 0
  v_cndmask_b32 v40, 0, v8, s[50:51]
  v_cndmask_b32 v44, 0, v8, s[52:53]
  v_cndmask_b32 v48, 0, v8, s[54:55]
  v_cndmask_b32 v52, 0, v8, vcc
  v_mov_b32 v41, v40
  v_mov_b32 v42, v40
  v_mov_b32 v43, v40
  v_mov_b32 v45, v44
  v_mov_b32 v46, v44
  v_mov_b32 v47, v44
  v_mov_b32 v49, v48
  v_mov_b32 v50, v48
  v_mov_b32 v51, v48
  v_mov_b32 v53, v52
  v_mov_b32 v54, v52
  v_mov_b32 v55, v52
  v_mov_b32 v124, 0
  v_mov_b32 v125, 0
  v_mov_b32 v126, 0
  v_mov_b32 v127, 0
  v_mov_b32 v128, 0
  v_mov_b32 v129, 0
  v_mov_b32 v130, 0
  v_mov_b32 v131, 0
  s_lshl_b32 s10, s28, 7
  s_lshl_b32 s11, s27, 6
  s_add_u32 s10, s10, s11
  v_lshl_add_u32 v118, v1, 2, s10
  v_xor_b32 v122, 64, v118
  v_bfe_u32 v3, v155, 2, 1
  v_lshl_add_u32 v3, v3, 4, v5
  v_lshl_add_u32 v3, v2, 2, v3
  v_lshlrev_b32 v3, 2, v3
  v_xor_b32 v119, s10, v3
  s_lshl_b32 s10, s27, 10
  v_add_u32 v121, s10, v158
  s_lshl_b32 s10, s28, 2
  v_add_u32 v120, s10, v121
  s_mov_b32 s50, 0x22222222
  s_mov_b32 s51, s50
  s_mov_b32 s52, 0x44444444
  s_mov_b32 s53, s52
  s_mov_b32 s54, 0x88888888
  s_mov_b32 s55, s54
  s_lshl_b32 s38, s29, 2
  s_add_u32 s38, s38, s28
  s_lshl_b32 s24, s3, 2
  s_bfe_u32 s10, s2, 0x20003
  s_add_u32 s24, s24, s10
  s_lshr_b32 s25, s2, 5
  s_mul_i32 s42, s25, 160
  s_mul_i32 s43, s24, 81920
  s_lshl_b32 s8, s33, 8
  s_lshl_b32 s10, s29, 2
  s_add_u32 s8, s8, s10
  s_lshl_b32 s10, s2, 2
  s_add_u32 s10, s10, 2880
  s_cmp_ge_u32 s2, 240
  s_cselect_b32 s8, s10, s8
  v_lshl_add_u32 v176, v155, 12, s8
  s_getreg_b32 s10, hwreg(HW_REG_XCC_ID, 0, 4)
  s_or_b32 s10, s10, 64
  v_mov_b32 v177, s10
  s_lshl_b32 s9, s3, 12
  s_lshr_b32 s8, s2, 3
  s_lshl_b32 s8, s8, 2
  s_add_u32 s8, s8, s9
  s_add_u32 s8, s8, 128
  v_writelane_b32 v176, s8, 8
  s_mov_b32 s8, 16711680
  s_add_u32 s9, s9, 16711680
  s_mul_i32 s10, s24, 20
  s_add_u32 s11, s10, 19
  s_lshr_b32 s10, s10, 7
  s_lshr_b32 s11, s11, 7
  s_sub_u32 s11, s11, s10
  v_min_u32 v3, 2, v2
  v_mul_u32_u24 v3, 5, v3
  v_bfe_u32 v4, v155, 3, 1
  v_mul_u32_u24 v4, s11, v4
  v_add3_u32 v3, v3, v4, s10
  v_and_b32 v4, 7, v155
  v_lshlrev_b32 v4, 3, v4
  v_lshl_add_u32 v160, v3, 8, v4
  v_and_b32 v4, 3, v155
  v_lshlrev_b32 v4, 4, v4
  v_lshrrev_b32 v3, 2, v155
  v_lshl_add_u32 v163, v3, 8, v4
  s_mov_b32 s75, 65536
  v_lshrrev_b32 v3, 3, v159
  v_and_b32 v4, 7, v159
  v_mul_u32_u24 v228, 1280, v3
  v_mul_u32_u24 v229, 20, v4
  v_add_u32 v228, v228, v229
  s_add_u32 s43, s43, s42
  v_mul_u32_u24 v227, 20, v155
  v_and_b32 v162, 3, v155
  v_lshl_add_u32 v162, v162, 2, 64
  v_add_u32 v162, 176, v162
  s_mov_b32 s66, 1280
  s_mov_b32 s67, 0x20000
  s_cmp_ge_u32 s2, 240
  s_cbranch_scc1 sequential_preLN__mha_block__moe_arch_mod__prompt_kernel_spare2
  s_cmp_ge_u32 s33, 10
  s_cbranch_scc1 sequential_preLN__mha_block__moe_arch_mod__prompt_kernel_vpath5
  s_cmp_ge_u32 s33, 5
  s_cselect_b32 s3, 5, 0
  s_mov_b32 s10, 1280
  s_cselect_b32 s10, 2560, s10
  s_mov_b32 s74, 81920
  s_cselect_b32 s74, 163840, s74
  s_cselect_b32 s11, 2621440, 0
  s_cselect_b32 s39, 1.0, 0x3ea52b5c
  s_sub_u32 s3, s33, s3
  s_mul_i32 s10, s10, s38
  s_add_u32 s11, s11, s10
  s_lshl_b32 s3, s3, 4
  s_lshl_b32 s10, s27, 3
  s_add_u32 s3, s3, s10
  s_lshl_b32 s10, s27, 4
  v_xor_b32 v9, s10, v156
  v_add_u32 v7, s3, v157
  v_lshlrev_b32 v8, 4, v9
  v_lshlrev_b32 v9, 3, v9
  v_add_u32 v9, 1024, v9
  v_mul_u32_u24 v1, 205, v7
  v_lshrrev_b32 v1, 10, v1
  v_mul_u32_u24 v2, 5, v1
  v_sub_u32 v2, v7, v2
  v_cmp_lt_u32 vcc, 2, v2
  v_lshlrev_b32 v1, 1, v1
  v_cmp_ne_u32 s[14:15], 2, v2
  v_lshrrev_b32 v3, 1, v2
  v_addc_co_u32 v1, vcc, 0, v1, vcc
  v_xor_b32 v3, v3, v2
  v_lshrrev_b32 v4, 2, v2
  v_xor_b32 v3, v3, v4
  v_and_b32 v3, 1, v3
  v_lshl_add_u32 v3, v3, 9, v8
  v_mul_u32_u24 v1, s74, v1
  v_add_u32 v7, 2, v7
  v_cndmask_b32 v3, v9, v3, s[14:15]
  v_add3_u32 v208, v1, v3, s11
  v_mul_u32_u24 v1, 205, v7
  v_lshrrev_b32 v1, 10, v1
  v_mul_u32_u24 v2, 5, v1
  v_sub_u32 v2, v7, v2
  v_cmp_lt_u32 vcc, 2, v2
  v_lshlrev_b32 v1, 1, v1
  v_cmp_ne_u32 s[18:19], 2, v2
  v_lshrrev_b32 v3, 1, v2
  v_addc_co_u32 v1, vcc, 0, v1, vcc
  v_xor_b32 v3, v3, v2
  v_lshrrev_b32 v4, 2, v2
  v_xor_b32 v3, v3, v4
  v_and_b32 v3, 1, v3
  v_lshl_add_u32 v3, v3, 9, v8
  v_mul_u32_u24 v1, s74, v1
  v_add_u32 v7, 2, v7
  v_cndmask_b32 v3, v9, v3, s[18:19]
  v_add3_u32 v209, v1, v3, s11
  v_mul_u32_u24 v1, 205, v7
  v_lshrrev_b32 v1, 10, v1
  v_mul_u32_u24 v2, 5, v1
  v_sub_u32 v2, v7, v2
  v_cmp_lt_u32 vcc, 2, v2
  v_lshlrev_b32 v1, 1, v1
  v_cmp_ne_u32 s[40:41], 2, v2
  v_lshrrev_b32 v3, 1, v2
  v_addc_co_u32 v1, vcc, 0, v1, vcc
  v_xor_b32 v3, v3, v2
  v_lshrrev_b32 v4, 2, v2
  v_xor_b32 v3, v3, v4
  v_and_b32 v3, 1, v3
  v_lshl_add_u32 v3, v3, 9, v8
  v_mul_u32_u24 v1, s74, v1
  v_add_u32 v7, 2, v7
  v_cndmask_b32 v3, v9, v3, s[40:41]
  v_add3_u32 v210, v1, v3, s11
  v_mul_u32_u24 v1, 205, v7
  v_lshrrev_b32 v1, 10, v1
  v_mul_u32_u24 v2, 5, v1
  v_sub_u32 v2, v7, v2
  v_cmp_lt_u32 vcc, 2, v2
  v_lshlrev_b32 v1, 1, v1
  v_cmp_ne_u32 s[46:47], 2, v2
  v_lshrrev_b32 v3, 1, v2
  v_addc_co_u32 v1, vcc, 0, v1, vcc
  v_xor_b32 v3, v3, v2
  v_lshrrev_b32 v4, 2, v2
  v_xor_b32 v3, v3, v4
  v_and_b32 v3, 1, v3
  v_lshl_add_u32 v3, v3, 9, v8
  v_mul_u32_u24 v1, s74, v1
  v_add_u32 v7, 2, v7
  v_cndmask_b32 v3, v9, v3, s[46:47]
  v_add3_u32 v211, v1, v3, s11
  s_cmp_ge_u32 s29, 8
  s_cselect_b32 s101, 1, 0
  s_cmp_ge_u32 s33, 5
  s_cselect_b32 s101, s101, 0
  v_mov_b32 v1, 0x40000000
  v_cndmask_b32 v212, v1, v208, s[14:15]
  v_cndmask_b32 v216, v208, v1, s[14:15]
  v_cndmask_b32 v213, v1, v209, s[18:19]
  v_cndmask_b32 v217, v209, v1, s[18:19]
  v_cndmask_b32 v214, v1, v210, s[40:41]
  v_cndmask_b32 v218, v210, v1, s[40:41]
  v_cndmask_b32 v215, v1, v211, s[46:47]
  v_cndmask_b32 v219, v211, v1, s[46:47]
  s_waitcnt vmcnt(4) lgkmcnt(0)
  s_barrier
  ds_read_b128 v[56:59], v104 offset:0
  ds_read_b64_tr_b16 v[72:73], v106 offset:0
  ds_read_b64_tr_b16 v[74:75], v106 offset:512
  ds_read_b128 v[60:63], v105 offset:0
  ds_read_b64_tr_b16 v[76:77], v107 offset:0
  ds_read_b64_tr_b16 v[78:79], v107 offset:512
  ds_read_b64_tr_b16 v[80:81], v108 offset:0
  ds_read_b64_tr_b16 v[82:83], v108 offset:512
  ds_read_b64_tr_b16 v[84:85], v109 offset:0
  ds_read_b64_tr_b16 v[86:87], v109 offset:512
  s_waitcnt lgkmcnt(4)
  v_mfma_f32_16x16x32_bf16 v[0:3], v[72:75], v[56:59], 0
  ds_read_b128 v[64:67], v136 offset:0
  ds_read_b64_tr_b16 v[88:89], v106 offset:4096
  v_mfma_f32_16x16x32_bf16 v[4:7], v[72:75], v[60:63], 0
  ds_read_b64_tr_b16 v[90:91], v106 offset:4608
  ds_read_b128 v[68:71], v137 offset:0
  v_mfma_f32_16x16x32_bf16 v[8:11], v[76:79], v[56:59], 0
  ds_read_b64_tr_b16 v[92:93], v107 offset:4096
  ds_read_b64_tr_b16 v[94:95], v107 offset:4608
  v_mfma_f32_16x16x32_bf16 v[12:15], v[76:79], v[60:63], 0
  ds_read_b64_tr_b16 v[96:97], v108 offset:4096
  ds_read_b64_tr_b16 v[98:99], v108 offset:4608
  v_mfma_f32_16x16x32_bf16 v[32:35], v[56:59], v[56:59], 0
  ds_read_b64_tr_b16 v[100:101], v109 offset:4096
  ds_read_b64_tr_b16 v[102:103], v109 offset:4608
  v_mfma_f32_16x16x32_bf16 v[132:135], v[40:43], v[56:59], 0
  s_waitcnt lgkmcnt(10)
  s_lshl_b32 s32, s34, 7
  s_add_u32 s32, s32, s36
  s_mul_i32 s35, s34, 245760
  s_add_u32 s35, s35, s37
  s_add_u32 m0, s30, 8192
  s_add_u32 s34, s34, 1
  buffer_load_dwordx4 v110, s[60:63], s32 offen lds
  v_mfma_f32_16x16x32_bf16 v[16:19], v[80:83], v[56:59], 0
  v_mfma_f32_16x16x32_bf16 v[20:23], v[80:83], v[60:63], 0
  s_add_u32 m0, s31, 16384
  s_cmp_eq_u32 s34, 10
  buffer_load_dwordx4 v112, s[68:71], s35 offen lds
  s_cselect_b32 s34, 0, s34
  v_mfma_f32_16x16x32_bf16 v[24:27], v[84:87], v[56:59], 0
  v_mfma_f32_16x16x32_bf16 v[28:31], v[84:87], v[60:63], 0
  s_add_u32 m0, s30, 10240
  s_nop 0
  buffer_load_dwordx4 v111, s[60:63], s32 offen lds
  s_cmp_eq_u32 s28, 0
  s_cbranch_scc0 sequential_preLN__mha_block__moe_arch_mod__prompt_kernel_cs7
  v_mfma_f32_16x16x32_bf16 v[36:39], v[40:43], v[72:75], v[36:39]
  v_mfma_f32_16x16x32_bf16 v[36:39], v[44:47], v[76:79], v[36:39]
  v_mfma_f32_16x16x32_bf16 v[36:39], v[48:51], v[80:83], v[36:39]
  v_mfma_f32_16x16x32_bf16 v[36:39], v[52:55], v[84:87], v[36:39]
sequential_preLN__mha_block__moe_arch_mod__prompt_kernel_cs7:
  s_waitcnt vmcnt(3) lgkmcnt(0)
  s_barrier
  v_mfma_f32_16x16x32_bf16 v[0:3], v[88:91], v[64:67], v[0:3]
  ds_read_b128 v[56:59], v104 offset:4096
  ds_read_b64_tr_b16 v[72:73], v106 offset:8192
  v_mfma_f32_16x16x32_bf16 v[4:7], v[88:91], v[68:71], v[4:7]
  ds_read_b64_tr_b16 v[74:75], v106 offset:8704
  ds_read_b128 v[60:63], v105 offset:4096
  v_mfma_f32_16x16x32_bf16 v[8:11], v[92:95], v[64:67], v[8:11]
  ds_read_b64_tr_b16 v[76:77], v107 offset:8192
  ds_read_b64_tr_b16 v[78:79], v107 offset:8704
  v_mfma_f32_16x16x32_bf16 v[12:15], v[92:95], v[68:71], v[12:15]
  ds_read_b64_tr_b16 v[80:81], v108 offset:8192
  ds_read_b64_tr_b16 v[82:83], v108 offset:8704
  v_mfma_f32_16x16x32_bf16 v[32:35], v[64:67], v[64:67], v[32:35]
  ds_read_b64_tr_b16 v[84:85], v109 offset:8192
  ds_read_b64_tr_b16 v[86:87], v109 offset:8704
  v_mfma_f32_16x16x32_bf16 v[132:135], v[40:43], v[64:67], v[132:135]
  s_add_u32 m0, s31, 57216
  s_nop 0
  buffer_load_dwordx4 v112, s[68:71], s35 offen offset:128 lds
  v_mfma_f32_16x16x32_bf16 v[16:19], v[96:99], v[64:67], v[16:19]
  v_mfma_f32_16x16x32_bf16 v[20:23], v[96:99], v[68:71], v[20:23]
  s_lshl_b32 s32, s34, 7
  s_add_u32 s32, s32, s36
  s_mul_i32 s35, s34, 245760
  s_add_u32 s35, s35, s37
  s_add_u32 m0, s30, 12288
  s_add_u32 s34, s34, 1
  buffer_load_dwordx4 v110, s[60:63], s32 offen lds
  v_mfma_f32_16x16x32_bf16 v[24:27], v[100:103], v[64:67], v[24:27]
  v_mfma_f32_16x16x32_bf16 v[28:31], v[100:103], v[68:71], v[28:31]
  s_add_u32 m0, s31, 24576
  s_cmp_eq_u32 s34, 10
  buffer_load_dwordx4 v112, s[68:71], s35 offen lds
  s_cselect_b32 s34, 0, s34
  s_cmp_eq_u32 s28, 1
  s_cbranch_scc0 sequential_preLN__mha_block__moe_arch_mod__prompt_kernel_cs8
  v_mfma_f32_16x16x32_bf16 v[36:39], v[40:43], v[88:91], v[36:39]
  v_mfma_f32_16x16x32_bf16 v[36:39], v[44:47], v[92:95], v[36:39]
  v_mfma_f32_16x16x32_bf16 v[36:39], v[48:51], v[96:99], v[36:39]
  v_mfma_f32_16x16x32_bf16 v[36:39], v[52:55], v[100:103], v[36:39]
sequential_preLN__mha_block__moe_arch_mod__prompt_kernel_cs8:
  s_waitcnt lgkmcnt(4)
  v_mfma_f32_16x16x32_bf16 v[0:3], v[72:75], v[56:59], v[0:3]
  ds_read_b128 v[64:67], v136 offset:4096
  ds_read_b64_tr_b16 v[88:89], v106 offset:12288
  v_mfma_f32_16x16x32_bf16 v[4:7], v[72:75], v[60:63], v[4:7]
  ds_read_b64_tr_b16 v[90:91], v106 offset:12800
  ds_read_b128 v[68:71], v137 offset:4096
  v_mfma_f32_16x16x32_bf16 v[8:11], v[76:79], v[56:59], v[8:11]
  ds_read_b64_tr_b16 v[92:93], v107 offset:12288
  ds_read_b64_tr_b16 v[94:95], v107 offset:12800
  v_mfma_f32_16x16x32_bf16 v[12:15], v[76:79], v[60:63], v[12:15]
  ds_read_b64_tr_b16 v[96:97], v108 offset:12288
  ds_read_b64_tr_b16 v[98:99], v108 offset:12800
  v_mfma_f32_16x16x32_bf16 v[32:35], v[56:59], v[56:59], v[32:35]
  ds_read_b64_tr_b16 v[100:101], v109 offset:12288
  ds_read_b64_tr_b16 v[102:103], v109 offset:12800
  v_mfma_f32_16x16x32_bf16 v[132:135], v[40:43], v[56:59], v[132:135]
  s_waitcnt lgkmcnt(10)
  s_add_u32 m0, s30, 14336
  s_nop 0
  buffer_load_dwordx4 v111, s[60:63], s32 offen lds
  v_mfma_f32_16x16x32_bf16 v[16:19], v[80:83], v[56:59], v[16:19]
  v_mfma_f32_16x16x32_bf16 v[20:23], v[80:83], v[60:63], v[20:23]
  s_add_u32 m0, s31, 65408
  s_nop 0
  buffer_load_dwordx4 v112, s[68:71], s35 offen offset:128 lds
  v_mfma_f32_16x16x32_bf16 v[24:27], v[84:87], v[56:59], v[24:27]
  v_mfma_f32_16x16x32_bf16 v[28:31], v[84:87], v[60:63], v[28:31]
  s_lshl_b32 s32, s34, 7
  s_add_u32 s32, s32, s36
  s_mul_i32 s35, s34, 245760
  s_add_u32 s35, s35, s37
  s_add_u32 m0, s30, 16384
  s_add_u32 s34, s34, 1
  buffer_load_dwordx4 v110, s[60:63], s32 offen lds
  s_cmp_eq_u32 s28, 2
  s_cbranch_scc0 sequential_preLN__mha_block__moe_arch_mod__prompt_kernel_cs9
  v_mfma_f32_16x16x32_bf16 v[36:39], v[40:43], v[72:75], v[36:39]
  v_mfma_f32_16x16x32_bf16 v[36:39], v[44:47], v[76:79], v[36:39]
  v_mfma_f32_16x16x32_bf16 v[36:39], v[48:51], v[80:83], v[36:39]
  v_mfma_f32_16x16x32_bf16 v[36:39], v[52:55], v[84:87], v[36:39]
sequential_preLN__mha_block__moe_arch_mod__prompt_kernel_cs9:
  s_waitcnt vmcnt(5) lgkmcnt(0)
  s_barrier
  v_mfma_f32_16x16x32_bf16 v[0:3], v[88:91], v[64:67], v[0:3]
  ds_read_b128 v[56:59], v104 offset:8192
  ds_read_b64_tr_b16 v[72:73], v106 offset:16384
  v_mfma_f32_16x16x32_bf16 v[4:7], v[88:91], v[68:71], v[4:7]
  ds_read_b64_tr_b16 v[74:75], v106 offset:16896
  ds_read_b128 v[60:63], v105 offset:8192
  v_mfma_f32_16x16x32_bf16 v[8:11], v[92:95], v[64:67], v[8:11]
  ds_read_b64_tr_b16 v[76:77], v107 offset:16384
  ds_read_b64_tr_b16 v[78:79], v107 offset:16896
  v_mfma_f32_16x16x32_bf16 v[12:15], v[92:95], v[68:71], v[12:15]
  ds_read_b64_tr_b16 v[80:81], v108 offset:16384
  ds_read_b64_tr_b16 v[82:83], v108 offset:16896
  v_mfma_f32_16x16x32_bf16 v[32:35], v[64:67], v[64:67], v[32:35]
  ds_read_b64_tr_b16 v[84:85], v109 offset:16384
  ds_read_b64_tr_b16 v[86:87], v109 offset:16896
  v_mfma_f32_16x16x32_bf16 v[132:135], v[40:43], v[64:67], v[132:135]
  s_add_u32 m0, s31, 32768
  s_cmp_eq_u32 s34, 10
  buffer_load_dwordx4 v112, s[68:71], s35 offen lds
  s_cselect_b32 s34, 0, s34
  v_mfma_f32_16x16x32_bf16 v[16:19], v[96:99], v[64:67], v[16:19]
  v_mfma_f32_16x16x32_bf16 v[20:23], v[96:99], v[68:71], v[20:23]
  s_add_u32 m0, s30, 18432
  s_nop 0
  buffer_load_dwordx4 v111, s[60:63], s32 offen lds
  v_mfma_f32_16x16x32_bf16 v[24:27], v[100:103], v[64:67], v[24:27]
  v_mfma_f32_16x16x32_bf16 v[28:31], v[100:103], v[68:71], v[28:31]
  s_add_u32 m0, s31, 73600
  s_nop 0
  buffer_load_dwordx4 v112, s[68:71], s35 offen offset:128 lds
  s_cmp_eq_u32 s28, 3
  s_cbranch_scc0 sequential_preLN__mha_block__moe_arch_mod__prompt_kernel_cs10
  v_mfma_f32_16x16x32_bf16 v[36:39], v[40:43], v[88:91], v[36:39]
  v_mfma_f32_16x16x32_bf16 v[36:39], v[44:47], v[92:95], v[36:39]
  v_mfma_f32_16x16x32_bf16 v[36:39], v[48:51], v[96:99], v[36:39]
  v_mfma_f32_16x16x32_bf16 v[36:39], v[52:55], v[100:103], v[36:39]
sequential_preLN__mha_block__moe_arch_mod__prompt_kernel_cs10:
  s_waitcnt lgkmcnt(4)
  v_mfma_f32_16x16x32_bf16 v[0:3], v[72:75], v[56:59], v[0:3]
  ds_read_b128 v[64:67], v136 offset:8192
  ds_read_b64_tr_b16 v[88:89], v106 offset:20480
  v_mfma_f32_16x16x32_bf16 v[4:7], v[72:75], v[60:63], v[4:7]
  ds_read_b64_tr_b16 v[90:91], v106 offset:20992
  ds_read_b128 v[68:71], v137 offset:8192
  v_mfma_f32_16x16x32_bf16 v[8:11], v[76:79], v[56:59], v[8:11]
  ds_read_b64_tr_b16 v[92:93], v107 offset:20480
  ds_read_b64_tr_b16 v[94:95], v107 offset:20992
  v_mfma_f32_16x16x32_bf16 v[12:15], v[76:79], v[60:63], v[12:15]
  ds_read_b64_tr_b16 v[96:97], v108 offset:20480
  ds_read_b64_tr_b16 v[98:99], v108 offset:20992
  v_mfma_f32_16x16x32_bf16 v[32:35], v[56:59], v[56:59], v[32:35]
  ds_read_b64_tr_b16 v[100:101], v109 offset:20480
  ds_read_b64_tr_b16 v[102:103], v109 offset:20992
  v_mfma_f32_16x16x32_bf16 v[132:135], v[40:43], v[56:59], v[132:135]
  s_waitcnt lgkmcnt(10)
  s_lshl_b32 s32, s34, 7
  s_add_u32 s32, s32, s36
  s_mul_i32 s35, s34, 245760
  s_add_u32 s35, s35, s37
  s_add_u32 m0, s30, 0
  s_add_u32 s34, s34, 1
  buffer_load_dwordx4 v110, s[60:63], s32 offen lds
  v_mfma_f32_16x16x32_bf16 v[16:19], v[80:83], v[56:59], v[16:19]
  v_mfma_f32_16x16x32_bf16 v[20:23], v[80:83], v[60:63], v[20:23]
  s_add_u32 m0, s31, 0
  s_cmp_eq_u32 s34, 10
  buffer_load_dwordx4 v112, s[68:71], s35 offen lds
  s_cselect_b32 s34, 0, s34
  v_mfma_f32_16x16x32_bf16 v[24:27], v[84:87], v[56:59], v[24:27]
  v_mfma_f32_16x16x32_bf16 v[28:31], v[84:87], v[60:63], v[28:31]
  s_add_u32 m0, s30, 2048
  s_nop 0
  buffer_load_dwordx4 v111, s[60:63], s32 offen lds
  s_cmp_eq_u32 s28, 0
  s_cbranch_scc0 sequential_preLN__mha_block__moe_arch_mod__prompt_kernel_cs11
  v_mfma_f32_16x16x32_bf16 v[36:39], v[40:43], v[72:75], v[36:39]
  v_mfma_f32_16x16x32_bf16 v[36:39], v[44:47], v[76:79], v[36:39]
  v_mfma_f32_16x16x32_bf16 v[36:39], v[48:51], v[80:83], v[36:39]
  v_mfma_f32_16x16x32_bf16 v[36:39], v[52:55], v[84:87], v[36:39]
sequential_preLN__mha_block__moe_arch_mod__prompt_kernel_cs11:
  s_waitcnt vmcnt(7) lgkmcnt(0)
  s_barrier
  v_mfma_f32_16x16x32_bf16 v[0:3], v[88:91], v[64:67], v[0:3]
  ds_read_b128 v[56:59], v104 offset:12288
  ds_read_b64_tr_b16 v[72:73], v106 offset:24576
  v_mfma_f32_16x16x32_bf16 v[4:7], v[88:91], v[68:71], v[4:7]
  ds_read_b64_tr_b16 v[74:75], v106 offset:25088
  ds_read_b128 v[60:63], v105 offset:12288
  v_mfma_f32_16x16x32_bf16 v[8:11], v[92:95], v[64:67], v[8:11]
  ds_read_b64_tr_b16 v[76:77], v107 offset:24576
  ds_read_b64_tr_b16 v[78:79], v107 offset:25088
  v_mfma_f32_16x16x32_bf16 v[12:15], v[92:95], v[68:71], v[12:15]
  ds_read_b64_tr_b16 v[80:81], v108 offset:24576
  ds_read_b64_tr_b16 v[82:83], v108 offset:25088
  v_mfma_f32_16x16x32_bf16 v[32:35], v[64:67], v[64:67], v[32:35]
  ds_read_b64_tr_b16 v[84:85], v109 offset:24576
  ds_read_b64_tr_b16 v[86:87], v109 offset:25088
  v_mfma_f32_16x16x32_bf16 v[132:135], v[40:43], v[64:67], v[132:135]
  s_add_u32 m0, s31, 40832
  s_nop 0
  buffer_load_dwordx4 v112, s[68:71], s35 offen offset:128 lds
  v_mfma_f32_16x16x32_bf16 v[16:19], v[96:99], v[64:67], v[16:19]
  v_mfma_f32_16x16x32_bf16 v[20:23], v[96:99], v[68:71], v[20:23]
  s_lshl_b32 s32, s34, 7
  s_add_u32 s32, s32, s36
  s_mul_i32 s35, s34, 245760
  s_add_u32 s35, s35, s37
  s_add_u32 m0, s30, 4096
  s_add_u32 s34, s34, 1
  buffer_load_dwordx4 v110, s[60:63], s32 offen lds
  v_mfma_f32_16x16x32_bf16 v[24:27], v[100:103], v[64:67], v[24:27]
  v_mfma_f32_16x16x32_bf16 v[28:31], v[100:103], v[68:71], v[28:31]
  s_add_u32 m0, s31, 8192
  s_cmp_eq_u32 s34, 10
  buffer_load_dwordx4 v112, s[68:71], s35 offen lds
  s_cselect_b32 s34, 0, s34
  s_cmp_eq_u32 s28, 1
  s_cbranch_scc0 sequential_preLN__mha_block__moe_arch_mod__prompt_kernel_cs12
  v_mfma_f32_16x16x32_bf16 v[36:39], v[40:43], v[88:91], v[36:39]
  v_mfma_f32_16x16x32_bf16 v[36:39], v[44:47], v[92:95], v[36:39]
  v_mfma_f32_16x16x32_bf16 v[36:39], v[48:51], v[96:99], v[36:39]
  v_mfma_f32_16x16x32_bf16 v[36:39], v[52:55], v[100:103], v[36:39]
sequential_preLN__mha_block__moe_arch_mod__prompt_kernel_cs12:
  s_waitcnt lgkmcnt(4)
  s_cmp_eq_u32 s26, 0
  s_cbranch_scc0 sequential_preLN__mha_block__moe_arch_mod__prompt_kernel_dl13
  buffer_load_dword v161, v162, s[56:59], 0 offen sc1
sequential_preLN__mha_block__moe_arch_mod__prompt_kernel_dl13:
  v_mfma_f32_16x16x32_bf16 v[0:3], v[72:75], v[56:59], v[0:3]
  ds_read_b128 v[64:67], v136 offset:12288
  ds_read_b64_tr_b16 v[88:89], v106 offset:28672
  v_mfma_f32_16x16x32_bf16 v[4:7], v[72:75], v[60:63], v[4:7]
  ds_read_b64_tr_b16 v[90:91], v106 offset:29184
  ds_read_b128 v[68:71], v137 offset:12288
  v_mfma_f32_16x16x32_bf16 v[8:11], v[76:79], v[56:59], v[8:11]
  ds_read_b64_tr_b16 v[92:93], v107 offset:28672
  ds_read_b64_tr_b16 v[94:95], v107 offset:29184
  v_mfma_f32_16x16x32_bf16 v[12:15], v[76:79], v[60:63], v[12:15]
  ds_read_b64_tr_b16 v[96:97], v108 offset:28672
  ds_read_b64_tr_b16 v[98:99], v108 offset:29184
  v_mfma_f32_16x16x32_bf16 v[32:35], v[56:59], v[56:59], v[32:35]
  ds_read_b64_tr_b16 v[100:101], v109 offset:28672
  ds_read_b64_tr_b16 v[102:103], v109 offset:29184
  v_mfma_f32_16x16x32_bf16 v[132:135], v[40:43], v[56:59], v[132:135]
  s_waitcnt lgkmcnt(10)
  s_add_u32 m0, s30, 6144
  s_nop 0
  buffer_load_dwordx4 v111, s[60:63], s32 offen lds
  v_mfma_f32_16x16x32_bf16 v[16:19], v[80:83], v[56:59], v[16:19]
  v_mfma_f32_16x16x32_bf16 v[20:23], v[80:83], v[60:63], v[20:23]
  s_add_u32 m0, s31, 49024
  s_nop 0
  buffer_load_dwordx4 v112, s[68:71], s35 offen offset:128 lds
  v_mfma_f32_16x16x32_bf16 v[24:27], v[84:87], v[56:59], v[24:27]
  v_mfma_f32_16x16x32_bf16 v[28:31], v[84:87], v[60:63], v[28:31]
  s_lshl_b32 s32, s34, 7
  s_add_u32 s32, s32, s36
  s_mul_i32 s35, s34, 245760
  s_add_u32 s35, s35, s37
  s_add_u32 m0, s30, 8192
  s_add_u32 s34, s34, 1
  buffer_load_dwordx4 v110, s[60:63], s32 offen lds
  s_cmp_eq_u32 s28, 2
  s_cbranch_scc0 sequential_preLN__mha_block__moe_arch_mod__prompt_kernel_cs14
  v_mfma_f32_16x16x32_bf16 v[36:39], v[40:43], v[72:75], v[36:39]
  v_mfma_f32_16x16x32_bf16 v[36:39], v[44:47], v[76:79], v[36:39]
  v_mfma_f32_16x16x32_bf16 v[36:39], v[48:51], v[80:83], v[36:39]
  v_mfma_f32_16x16x32_bf16 v[36:39], v[52:55], v[84:87], v[36:39]
sequential_preLN__mha_block__moe_arch_mod__prompt_kernel_cs14:
  s_waitcnt vmcnt(9) lgkmcnt(0)
  s_barrier
  v_mfma_f32_16x16x32_bf16 v[0:3], v[88:91], v[64:67], v[0:3]
  ds_read_b128 v[56:59], v104 offset:16384
  ds_read_b64_tr_b16 v[72:73], v106 offset:32768
  v_mfma_f32_16x16x32_bf16 v[4:7], v[88:91], v[68:71], v[4:7]
  ds_read_b64_tr_b16 v[74:75], v106 offset:33280
  ds_read_b128 v[60:63], v105 offset:16384
  v_mfma_f32_16x16x32_bf16 v[8:11], v[92:95], v[64:67], v[8:11]
  ds_read_b64_tr_b16 v[76:77], v107 offset:32768
  ds_read_b64_tr_b16 v[78:79], v107 offset:33280
  v_mfma_f32_16x16x32_bf16 v[12:15], v[92:95], v[68:71], v[12:15]
  ds_read_b64_tr_b16 v[80:81], v108 offset:32768
  ds_read_b64_tr_b16 v[82:83], v108 offset:33280
  v_mfma_f32_16x16x32_bf16 v[32:35], v[64:67], v[64:67], v[32:35]
  ds_read_b64_tr_b16 v[84:85], v109 offset:32768
  ds_read_b64_tr_b16 v[86:87], v109 offset:33280
  v_mfma_f32_16x16x32_bf16 v[132:135], v[40:43], v[64:67], v[132:135]
  s_add_u32 m0, s31, 16384
  s_cmp_eq_u32 s34, 10
  buffer_load_dwordx4 v112, s[68:71], s35 offen lds
  s_cselect_b32 s34, 0, s34
  v_mfma_f32_16x16x32_bf16 v[16:19], v[96:99], v[64:67], v[16:19]
  v_mfma_f32_16x16x32_bf16 v[20:23], v[96:99], v[68:71], v[20:23]
  s_add_u32 m0, s30, 10240
  s_nop 0
  buffer_load_dwordx4 v111, s[60:63], s32 offen lds
  v_mfma_f32_16x16x32_bf16 v[24:27], v[100:103], v[64:67], v[24:27]
  v_mfma_f32_16x16x32_bf16 v[28:31], v[100:103], v[68:71], v[28:31]
  s_add_u32 m0, s31, 57216
  s_nop 0
  buffer_load_dwordx4 v112, s[68:71], s35 offen offset:128 lds
  s_cmp_eq_u32 s28, 3
  s_cbranch_scc0 sequential_preLN__mha_block__moe_arch_mod__prompt_kernel_cs15
  v_mfma_f32_16x16x32_bf16 v[36:39], v[40:43], v[88:91], v[36:39]
  v_mfma_f32_16x16x32_bf16 v[36:39], v[44:47], v[92:95], v[36:39]
  v_mfma_f32_16x16x32_bf16 v[36:39], v[48:51], v[96:99], v[36:39]
  v_mfma_f32_16x16x32_bf16 v[36:39], v[52:55], v[100:103], v[36:39]
sequential_preLN__mha_block__moe_arch_mod__prompt_kernel_cs15:
  s_waitcnt lgkmcnt(4)
  v_mfma_f32_16x16x32_bf16 v[0:3], v[72:75], v[56:59], v[0:3]
  ds_read_b128 v[64:67], v136 offset:16384
  ds_read_b64_tr_b16 v[88:89], v106 offset:36864
  v_mfma_f32_16x16x32_bf16 v[4:7], v[72:75], v[60:63], v[4:7]
  ds_read_b64_tr_b16 v[90:91], v106 offset:37376
  ds_read_b128 v[68:71], v137 offset:16384
  v_mfma_f32_16x16x32_bf16 v[8:11], v[76:79], v[56:59], v[8:11]
  ds_read_b64_tr_b16 v[92:93], v107 offset:36864
  ds_read_b64_tr_b16 v[94:95], v107 offset:37376
  v_mfma_f32_16x16x32_bf16 v[12:15], v[76:79], v[60:63], v[12:15]
  ds_read_b64_tr_b16 v[96:97], v108 offset:36864
  ds_read_b64_tr_b16 v[98:99], v108 offset:37376
  v_mfma_f32_16x16x32_bf16 v[32:35], v[56:59], v[56:59], v[32:35]
  ds_read_b64_tr_b16 v[100:101], v109 offset:36864
  ds_read_b64_tr_b16 v[102:103], v109 offset:37376
  v_mfma_f32_16x16x32_bf16 v[132:135], v[40:43], v[56:59], v[132:135]
  s_waitcnt lgkmcnt(10)
  s_lshl_b32 s32, s34, 7
  s_add_u32 s32, s32, s36
  s_mul_i32 s35, s34, 245760
  s_add_u32 s35, s35, s37
  s_add_u32 m0, s30, 12288
  s_add_u32 s34, s34, 1
  buffer_load_dwordx4 v110, s[60:63], s32 offen lds
  v_mfma_f32_16x16x32_bf16 v[16:19], v[80:83], v[56:59], v[16:19]
  v_mfma_f32_16x16x32_bf16 v[20:23], v[80:83], v[60:63], v[20:23]
  s_add_u32 m0, s31, 24576
  s_cmp_eq_u32 s34, 10
  buffer_load_dwordx4 v112, s[68:71], s35 offen lds
  s_cselect_b32 s34, 0, s34
  v_mfma_f32_16x16x32_bf16 v[24:27], v[84:87], v[56:59], v[24:27]
  v_mfma_f32_16x16x32_bf16 v[28:31], v[84:87], v[60:63], v[28:31]
  s_add_u32 m0, s30, 14336
  s_nop 0
  buffer_load_dwordx4 v111, s[60:63], s32 offen lds
  s_cmp_eq_u32 s28, 0
  s_cbranch_scc0 sequential_preLN__mha_block__moe_arch_mod__prompt_kernel_cs16
  v_mfma_f32_16x16x32_bf16 v[36:39], v[40:43], v[72:75], v[36:39]
  v_mfma_f32_16x16x32_bf16 v[36:39], v[44:47], v[76:79], v[36:39]
  v_mfma_f32_16x16x32_bf16 v[36:39], v[48:51], v[80:83], v[36:39]
  v_mfma_f32_16x16x32_bf16 v[36:39], v[52:55], v[84:87], v[36:39]
sequential_preLN__mha_block__moe_arch_mod__prompt_kernel_cs16:
  s_waitcnt vmcnt(11) lgkmcnt(0)
  s_barrier
  v_mfma_f32_16x16x32_bf16 v[0:3], v[88:91], v[64:67], v[0:3]
  ds_read_b128 v[56:59], v104 offset:0
  ds_read_b64_tr_b16 v[72:73], v106 offset:0
  v_mfma_f32_16x16x32_bf16 v[4:7], v[88:91], v[68:71], v[4:7]
  ds_read_b64_tr_b16 v[74:75], v106 offset:512
  ds_read_b128 v[60:63], v105 offset:0
  v_mfma_f32_16x16x32_bf16 v[8:11], v[92:95], v[64:67], v[8:11]
  ds_read_b64_tr_b16 v[76:77], v107 offset:0
  ds_read_b64_tr_b16 v[78:79], v107 offset:512
  v_mfma_f32_16x16x32_bf16 v[12:15], v[92:95], v[68:71], v[12:15]
  ds_read_b64_tr_b16 v[80:81], v108 offset:0
  ds_read_b64_tr_b16 v[82:83], v108 offset:512
  v_mfma_f32_16x16x32_bf16 v[32:35], v[64:67], v[64:67], v[32:35]
  ds_read_b64_tr_b16 v[84:85], v109 offset:0
  ds_read_b64_tr_b16 v[86:87], v109 offset:512
  v_mfma_f32_16x16x32_bf16 v[132:135], v[40:43], v[64:67], v[132:135]
  s_add_u32 m0, s31, 65408
  s_nop 0
  buffer_load_dwordx4 v112, s[68:71], s35 offen offset:128 lds
  v_mfma_f32_16x16x32_bf16 v[16:19], v[96:99], v[64:67], v[16:19]
  v_mfma_f32_16x16x32_bf16 v[20:23], v[96:99], v[68:71], v[20:23]
  s_lshl_b32 s32, s34, 7
  s_add_u32 s32, s32, s36
  s_mul_i32 s35, s34, 245760
  s_add_u32 s35, s35, s37
  s_add_u32 m0, s30, 16384
  s_add_u32 s34, s34, 1
  buffer_load_dwordx4 v110, s[60:63], s32 offen lds
  v_mfma_f32_16x16x32_bf16 v[24:27], v[100:103], v[64:67], v[24:27]
  v_mfma_f32_16x16x32_bf16 v[28:31], v[100:103], v[68:71], v[28:31]
  s_add_u32 m0, s31, 32768
  s_cmp_eq_u32 s34, 10
  buffer_load_dwordx4 v112, s[68:71], s35 offen lds
  s_cselect_b32 s34, 0, s34
  s_cmp_eq_u32 s28, 1
  s_cbranch_scc0 sequential_preLN__mha_block__moe_arch_mod__prompt_kernel_cs17
  v_mfma_f32_16x16x32_bf16 v[36:39], v[40:43], v[88:91], v[36:39]
  v_mfma_f32_16x16x32_bf16 v[36:39], v[44:47], v[92:95], v[36:39]
  v_mfma_f32_16x16x32_bf16 v[36:39], v[48:51], v[96:99], v[36:39]
  v_mfma_f32_16x16x32_bf16 v[36:39], v[52:55], v[100:103], v[36:39]
sequential_preLN__mha_block__moe_arch_mod__prompt_kernel_cs17:
  s_waitcnt lgkmcnt(4)
  v_mfma_f32_16x16x32_bf16 v[0:3], v[72:75], v[56:59], v[0:3]
  ds_read_b128 v[64:67], v136 offset:0
  ds_read_b64_tr_b16 v[88:89], v106 offset:4096
  v_mfma_f32_16x16x32_bf16 v[4:7], v[72:75], v[60:63], v[4:7]
  ds_read_b64_tr_b16 v[90:91], v106 offset:4608
  ds_read_b128 v[68:71], v137 offset:0
  v_mfma_f32_16x16x32_bf16 v[8:11], v[76:79], v[56:59], v[8:11]
  ds_read_b64_tr_b16 v[92:93], v107 offset:4096
  ds_read_b64_tr_b16 v[94:95], v107 offset:4608
  v_mfma_f32_16x16x32_bf16 v[12:15], v[76:79], v[60:63], v[12:15]
  ds_read_b64_tr_b16 v[96:97], v108 offset:4096
  ds_read_b64_tr_b16 v[98:99], v108 offset:4608
  v_mfma_f32_16x16x32_bf16 v[32:35], v[56:59], v[56:59], v[32:35]
  ds_read_b64_tr_b16 v[100:101], v109 offset:4096
  ds_read_b64_tr_b16 v[102:103], v109 offset:4608
  v_mfma_f32_16x16x32_bf16 v[132:135], v[40:43], v[56:59], v[132:135]
  s_waitcnt lgkmcnt(10)
  v_mfma_f32_16x16x32_bf16 v[16:19], v[80:83], v[56:59], v[16:19]
  v_mfma_f32_16x16x32_bf16 v[20:23], v[80:83], v[60:63], v[20:23]
  s_add_u32 m0, s30, 18432
  s_nop 0
  buffer_load_dwordx4 v111, s[60:63], s32 offen lds
  v_mfma_f32_16x16x32_bf16 v[24:27], v[84:87], v[56:59], v[24:27]
  v_mfma_f32_16x16x32_bf16 v[28:31], v[84:87], v[60:63], v[28:31]
  s_add_u32 m0, s31, 73600
  s_nop 0
  buffer_load_dwordx4 v112, s[68:71], s35 offen offset:128 lds
  s_cmp_eq_u32 s28, 2
  s_cbranch_scc0 sequential_preLN__mha_block__moe_arch_mod__prompt_kernel_cs18
  v_mfma_f32_16x16x32_bf16 v[36:39], v[40:43], v[72:75], v[36:39]
  v_mfma_f32_16x16x32_bf16 v[36:39], v[44:47], v[76:79], v[36:39]
  v_mfma_f32_16x16x32_bf16 v[36:39], v[48:51], v[80:83], v[36:39]
  v_mfma_f32_16x16x32_bf16 v[36:39], v[52:55], v[84:87], v[36:39]
sequential_preLN__mha_block__moe_arch_mod__prompt_kernel_cs18:
  s_waitcnt vmcnt(12) lgkmcnt(0)
  s_barrier
  s_cmp_eq_u32 s26, 0
  s_cbranch_scc0 sequential_preLN__mha_block__moe_arch_mod__prompt_kernel_fr19
  s_mov_b32 s3, 0x80808080
  s_waitcnt vmcnt(14)
sequential_preLN__mha_block__moe_arch_mod__prompt_kernel_dchk20:
  v_and_b32 v164, s3, v161
  v_cmp_ne_u32 vcc, s3, v164
  s_nop 4
  s_cbranch_vccz sequential_preLN__mha_block__moe_arch_mod__prompt_kernel_dok21
  s_sub_u32 s75, s75, 1
  s_cbranch_scc1 sequential_preLN__mha_block__moe_arch_mod__prompt_kernel_end1
  buffer_load_dword v161, v162, s[56:59], 0 offen sc1
  s_waitcnt vmcnt(0)
  s_branch sequential_preLN__mha_block__moe_arch_mod__prompt_kernel_dchk20
sequential_preLN__mha_block__moe_arch_mod__prompt_kernel_dok21:
sequential_preLN__mha_block__moe_arch_mod__prompt_kernel_fr19:
  v_mfma_f32_16x16x32_bf16 v[0:3], v[88:91], v[64:67], v[0:3]
  ds_read_b128 v[56:59], v104 offset:4096
  ds_read_b64_tr_b16 v[72:73], v106 offset:8192
  v_mfma_f32_16x16x32_bf16 v[4:7], v[88:91], v[68:71], v[4:7]
  ds_read_b64_tr_b16 v[74:75], v106 offset:8704
  ds_read_b128 v[60:63], v105 offset:4096
  v_mfma_f32_16x16x32_bf16 v[8:11], v[92:95], v[64:67], v[8:11]
  ds_read_b64_tr_b16 v[76:77], v107 offset:8192
  ds_read_b64_tr_b16 v[78:79], v107 offset:8704
  v_mfma_f32_16x16x32_bf16 v[12:15], v[92:95], v[68:71], v[12:15]
  ds_read_b64_tr_b16 v[80:81], v108 offset:8192
  ds_read_b64_tr_b16 v[82:83], v108 offset:8704
  v_mfma_f32_16x16x32_bf16 v[32:35], v[64:67], v[64:67], v[32:35]
  ds_read_b64_tr_b16 v[84:85], v109 offset:8192
  ds_read_b64_tr_b16 v[86:87], v109 offset:8704
  v_mfma_f32_16x16x32_bf16 v[132:135], v[40:43], v[64:67], v[132:135]
  v_mfma_f32_16x16x32_bf16 v[16:19], v[96:99], v[64:67], v[16:19]
  v_mfma_f32_16x16x32_bf16 v[20:23], v[96:99], v[68:71], v[20:23]
  buffer_load_dwordx4 v[178:181], v228, s[60:63], s43 offen
  v_mfma_f32_16x16x32_bf16 v[24:27], v[100:103], v[64:67], v[24:27]
  v_mfma_f32_16x16x32_bf16 v[28:31], v[100:103], v[68:71], v[28:31]
  buffer_load_dword v182, v228, s[60:63], s43 offen offset:16
  s_cmp_eq_u32 s28, 3
  s_cbranch_scc0 sequential_preLN__mha_block__moe_arch_mod__prompt_kernel_cs22
  v_mfma_f32_16x16x32_bf16 v[36:39], v[40:43], v[88:91], v[36:39]
  v_mfma_f32_16x16x32_bf16 v[36:39], v[44:47], v[92:95], v[36:39]
  v_mfma_f32_16x16x32_bf16 v[36:39], v[48:51], v[96:99], v[36:39]
  v_mfma_f32_16x16x32_bf16 v[36:39], v[52:55], v[100:103], v[36:39]
sequential_preLN__mha_block__moe_arch_mod__prompt_kernel_cs22:
  s_waitcnt lgkmcnt(4)
  v_mfma_f32_16x16x32_bf16 v[0:3], v[72:75], v[56:59], v[0:3]
  ds_read_b128 v[64:67], v136 offset:4096
  ds_read_b64_tr_b16 v[88:89], v106 offset:12288
  v_mfma_f32_16x16x32_bf16 v[4:7], v[72:75], v[60:63], v[4:7]
  ds_read_b64_tr_b16 v[90:91], v106 offset:12800
  ds_read_b128 v[68:71], v137 offset:4096
  v_mfma_f32_16x16x32_bf16 v[8:11], v[76:79], v[56:59], v[8:11]
  ds_read_b64_tr_b16 v[92:93], v107 offset:12288
  ds_read_b64_tr_b16 v[94:95], v107 offset:12800
  v_mfma_f32_16x16x32_bf16 v[12:15], v[76:79], v[60:63], v[12:15]
  ds_read_b64_tr_b16 v[96:97], v108 offset:12288
  ds_read_b64_tr_b16 v[98:99], v108 offset:12800
  v_mfma_f32_16x16x32_bf16 v[32:35], v[56:59], v[56:59], v[32:35]
  ds_read_b64_tr_b16 v[100:101], v109 offset:12288
  ds_read_b64_tr_b16 v[102:103], v109 offset:12800
  v_mfma_f32_16x16x32_bf16 v[132:135], v[40:43], v[56:59], v[132:135]
  s_waitcnt lgkmcnt(10)
  v_mfma_f32_16x16x32_bf16 v[16:19], v[80:83], v[56:59], v[16:19]
  v_mfma_f32_16x16x32_bf16 v[20:23], v[80:83], v[60:63], v[20:23]
  buffer_load_dwordx4 v[184:187], v229, s[64:67], s42 offen
  v_mfma_f32_16x16x32_bf16 v[24:27], v[84:87], v[56:59], v[24:27]
  v_mfma_f32_16x16x32_bf16 v[28:31], v[84:87], v[60:63], v[28:31]
  buffer_load_dword v188, v229, s[64:67], s42 offen offset:16
  s_cmp_eq_u32 s28, 0
  s_cbranch_scc0 sequential_preLN__mha_block__moe_arch_mod__prompt_kernel_cs23
  v_mfma_f32_16x16x32_bf16 v[36:39], v[40:43], v[72:75], v[36:39]
  v_mfma_f32_16x16x32_bf16 v[36:39], v[44:47], v[76:79], v[36:39]
  v_mfma_f32_16x16x32_bf16 v[36:39], v[48:51], v[80:83], v[36:39]
  v_mfma_f32_16x16x32_bf16 v[36:39], v[52:55], v[84:87], v[36:39]
sequential_preLN__mha_block__moe_arch_mod__prompt_kernel_cs23:
  s_waitcnt vmcnt(12) lgkmcnt(0)
  s_barrier
  v_mfma_f32_16x16x32_bf16 v[0:3], v[88:91], v[64:67], v[0:3]
  ds_read_b128 v[56:59], v104 offset:8192
  ds_read_b64_tr_b16 v[72:73], v106 offset:16384
  v_mfma_f32_16x16x32_bf16 v[4:7], v[88:91], v[68:71], v[4:7]
  ds_read_b64_tr_b16 v[74:75], v106 offset:16896
  ds_read_b128 v[60:63], v105 offset:8192
  v_mfma_f32_16x16x32_bf16 v[8:11], v[92:95], v[64:67], v[8:11]
  ds_read_b64_tr_b16 v[76:77], v107 offset:16384
  ds_read_b64_tr_b16 v[78:79], v107 offset:16896
  v_mfma_f32_16x16x32_bf16 v[12:15], v[92:95], v[68:71], v[12:15]
  ds_read_b64_tr_b16 v[80:81], v108 offset:16384
  ds_read_b64_tr_b16 v[82:83], v108 offset:16896
  v_mfma_f32_16x16x32_bf16 v[32:35], v[64:67], v[64:67], v[32:35]
  ds_read_b64_tr_b16 v[84:85], v109 offset:16384
  ds_read_b64_tr_b16 v[86:87], v109 offset:16896
  v_mfma_f32_16x16x32_bf16 v[132:135], v[40:43], v[64:67], v[132:135]
  v_mfma_f32_16x16x32_bf16 v[16:19], v[96:99], v[64:67], v[16:19]
  v_mfma_f32_16x16x32_bf16 v[20:23], v[96:99], v[68:71], v[20:23]
  buffer_load_dwordx4 v[222:225], v227, s[64:67], 0 offen
  v_mfma_f32_16x16x32_bf16 v[24:27], v[100:103], v[64:67], v[24:27]
  v_mfma_f32_16x16x32_bf16 v[28:31], v[100:103], v[68:71], v[28:31]
  buffer_load_dword v226, v227, s[64:67], 0 offen offset:16
  s_cmp_eq_u32 s28, 1
  s_cbranch_scc0 sequential_preLN__mha_block__moe_arch_mod__prompt_kernel_cs24
  v_mfma_f32_16x16x32_bf16 v[36:39], v[40:43], v[88:91], v[36:39]
  v_mfma_f32_16x16x32_bf16 v[36:39], v[44:47], v[92:95], v[36:39]
  v_mfma_f32_16x16x32_bf16 v[36:39], v[48:51], v[96:99], v[36:39]
  v_mfma_f32_16x16x32_bf16 v[36:39], v[52:55], v[100:103], v[36:39]
sequential_preLN__mha_block__moe_arch_mod__prompt_kernel_cs24:
  s_waitcnt lgkmcnt(4)
  v_mfma_f32_16x16x32_bf16 v[0:3], v[72:75], v[56:59], v[0:3]
  ds_read_b128 v[64:67], v136 offset:8192
  ds_read_b64_tr_b16 v[88:89], v106 offset:20480
  v_mfma_f32_16x16x32_bf16 v[4:7], v[72:75], v[60:63], v[4:7]
  ds_read_b64_tr_b16 v[90:91], v106 offset:20992
  ds_read_b128 v[68:71], v137 offset:8192
  v_mfma_f32_16x16x32_bf16 v[8:11], v[76:79], v[56:59], v[8:11]
  ds_read_b64_tr_b16 v[92:93], v107 offset:20480
  ds_read_b64_tr_b16 v[94:95], v107 offset:20992
  v_mfma_f32_16x16x32_bf16 v[12:15], v[76:79], v[60:63], v[12:15]
  ds_read_b64_tr_b16 v[96:97], v108 offset:20480
  ds_read_b64_tr_b16 v[98:99], v108 offset:20992
  v_mfma_f32_16x16x32_bf16 v[32:35], v[56:59], v[56:59], v[32:35]
  ds_read_b64_tr_b16 v[100:101], v109 offset:20480
  ds_read_b64_tr_b16 v[102:103], v109 offset:20992
  v_mfma_f32_16x16x32_bf16 v[132:135], v[40:43], v[56:59], v[132:135]
  s_waitcnt lgkmcnt(10)
  v_mfma_f32_16x16x32_bf16 v[16:19], v[80:83], v[56:59], v[16:19]
  v_mfma_f32_16x16x32_bf16 v[20:23], v[80:83], v[60:63], v[20:23]
  v_mfma_f32_16x16x32_bf16 v[24:27], v[84:87], v[56:59], v[24:27]
  v_mfma_f32_16x16x32_bf16 v[28:31], v[84:87], v[60:63], v[28:31]
  s_cmp_eq_u32 s28, 2
  s_cbranch_scc0 sequential_preLN__mha_block__moe_arch_mod__prompt_kernel_cs25
  v_mfma_f32_16x16x32_bf16 v[36:39], v[40:43], v[72:75], v[36:39]
  v_mfma_f32_16x16x32_bf16 v[36:39], v[44:47], v[76:79], v[36:39]
  v_mfma_f32_16x16x32_bf16 v[36:39], v[48:51], v[80:83], v[36:39]
  v_mfma_f32_16x16x32_bf16 v[36:39], v[52:55], v[84:87], v[36:39]
sequential_preLN__mha_block__moe_arch_mod__prompt_kernel_cs25:
  s_waitcnt vmcnt(10) lgkmcnt(0)
  s_barrier
  v_mfma_f32_16x16x32_bf16 v[0:3], v[88:91], v[64:67], v[0:3]
  ds_read_b128 v[56:59], v104 offset:12288
  ds_read_b64_tr_b16 v[72:73], v106 offset:24576
  v_mfma_f32_16x16x32_bf16 v[4:7], v[88:91], v[68:71], v[4:7]
  ds_read_b64_tr_b16 v[74:75], v106 offset:25088
  ds_read_b128 v[60:63], v105 offset:12288
  v_mfma_f32_16x16x32_bf16 v[8:11], v[92:95], v[64:67], v[8:11]
  ds_read_b64_tr_b16 v[76:77], v107 offset:24576
  ds_read_b64_tr_b16 v[78:79], v107 offset:25088
  v_mfma_f32_16x16x32_bf16 v[12:15], v[92:95], v[68:71], v[12:15]
  ds_read_b64_tr_b16 v[80:81], v108 offset:24576
  ds_read_b64_tr_b16 v[82:83], v108 offset:25088
  v_mfma_f32_16x16x32_bf16 v[32:35], v[64:67], v[64:67], v[32:35]
  ds_read_b64_tr_b16 v[84:85], v109 offset:24576
  ds_read_b64_tr_b16 v[86:87], v109 offset:25088
  v_mfma_f32_16x16x32_bf16 v[132:135], v[40:43], v[64:67], v[132:135]
  v_mfma_f32_16x16x32_bf16 v[16:19], v[96:99], v[64:67], v[16:19]
  v_mfma_f32_16x16x32_bf16 v[20:23], v[96:99], v[68:71], v[20:23]
  v_mfma_f32_16x16x32_bf16 v[24:27], v[100:103], v[64:67], v[24:27]
  v_mfma_f32_16x16x32_bf16 v[28:31], v[100:103], v[68:71], v[28:31]
  s_cmp_eq_u32 s28, 3
  s_cbranch_scc0 sequential_preLN__mha_block__moe_arch_mod__prompt_kernel_cs26
  v_mfma_f32_16x16x32_bf16 v[36:39], v[40:43], v[88:91], v[36:39]
  v_mfma_f32_16x16x32_bf16 v[36:39], v[44:47], v[92:95], v[36:39]
  v_mfma_f32_16x16x32_bf16 v[36:39], v[48:51], v[96:99], v[36:39]
  v_mfma_f32_16x16x32_bf16 v[36:39], v[52:55], v[100:103], v[36:39]
sequential_preLN__mha_block__moe_arch_mod__prompt_kernel_cs26:
  s_waitcnt lgkmcnt(4)
  v_mfma_f32_16x16x32_bf16 v[0:3], v[72:75], v[56:59], v[0:3]
  ds_read_b128 v[64:67], v136 offset:12288
  ds_read_b64_tr_b16 v[88:89], v106 offset:28672
  v_mfma_f32_16x16x32_bf16 v[4:7], v[72:75], v[60:63], v[4:7]
  ds_read_b64_tr_b16 v[90:91], v106 offset:29184
  ds_read_b128 v[68:71], v137 offset:12288
  v_mfma_f32_16x16x32_bf16 v[8:11], v[76:79], v[56:59], v[8:11]
  ds_read_b64_tr_b16 v[92:93], v107 offset:28672
  ds_read_b64_tr_b16 v[94:95], v107 offset:29184
  v_mfma_f32_16x16x32_bf16 v[12:15], v[76:79], v[60:63], v[12:15]
  ds_read_b64_tr_b16 v[96:97], v108 offset:28672
  ds_read_b64_tr_b16 v[98:99], v108 offset:29184
  v_mfma_f32_16x16x32_bf16 v[32:35], v[56:59], v[56:59], v[32:35]
  ds_read_b64_tr_b16 v[100:101], v109 offset:28672
  ds_read_b64_tr_b16 v[102:103], v109 offset:29184
  v_mfma_f32_16x16x32_bf16 v[132:135], v[40:43], v[56:59], v[132:135]
  s_waitcnt lgkmcnt(10)
  v_mfma_f32_16x16x32_bf16 v[16:19], v[80:83], v[56:59], v[16:19]
  v_mfma_f32_16x16x32_bf16 v[20:23], v[80:83], v[60:63], v[20:23]
  v_mfma_f32_16x16x32_bf16 v[24:27], v[84:87], v[56:59], v[24:27]
  v_mfma_f32_16x16x32_bf16 v[28:31], v[84:87], v[60:63], v[28:31]
  s_cmp_eq_u32 s28, 0
  s_cbranch_scc0 sequential_preLN__mha_block__moe_arch_mod__prompt_kernel_cs27
  v_mfma_f32_16x16x32_bf16 v[36:39], v[40:43], v[72:75], v[36:39]
  v_mfma_f32_16x16x32_bf16 v[36:39], v[44:47], v[76:79], v[36:39]
  v_mfma_f32_16x16x32_bf16 v[36:39], v[48:51], v[80:83], v[36:39]
  v_mfma_f32_16x16x32_bf16 v[36:39], v[52:55], v[84:87], v[36:39]
sequential_preLN__mha_block__moe_arch_mod__prompt_kernel_cs27:
  s_waitcnt vmcnt(6) lgkmcnt(0)
  s_barrier
  v_mfma_f32_16x16x32_bf16 v[0:3], v[88:91], v[64:67], v[0:3]
  ds_read_b128 v[56:59], v104 offset:16384
  ds_read_b64_tr_b16 v[72:73], v106 offset:32768
  v_mfma_f32_16x16x32_bf16 v[4:7], v[88:91], v[68:71], v[4:7]
  ds_read_b64_tr_b16 v[74:75], v106 offset:33280
  ds_read_b128 v[60:63], v105 offset:16384
  v_mfma_f32_16x16x32_bf16 v[8:11], v[92:95], v[64:67], v[8:11]
  ds_read_b64_tr_b16 v[76:77], v107 offset:32768
  ds_read_b64_tr_b16 v[78:79], v107 offset:33280
  v_mfma_f32_16x16x32_bf16 v[12:15], v[92:95], v[68:71], v[12:15]
  ds_read_b64_tr_b16 v[80:81], v108 offset:32768
  ds_read_b64_tr_b16 v[82:83], v108 offset:33280
  v_mfma_f32_16x16x32_bf16 v[32:35], v[64:67], v[64:67], v[32:35]
  ds_read_b64_tr_b16 v[84:85], v109 offset:32768
  ds_read_b64_tr_b16 v[86:87], v109 offset:33280
  v_mfma_f32_16x16x32_bf16 v[132:135], v[40:43], v[64:67], v[132:135]
  v_mfma_f32_16x16x32_bf16 v[16:19], v[96:99], v[64:67], v[16:19]
  v_mfma_f32_16x16x32_bf16 v[20:23], v[96:99], v[68:71], v[20:23]
  v_mfma_f32_16x16x32_bf16 v[24:27], v[100:103], v[64:67], v[24:27]
  v_mfma_f32_16x16x32_bf16 v[28:31], v[100:103], v[68:71], v[28:31]
  s_cmp_eq_u32 s28, 1
  s_cbranch_scc0 sequential_preLN__mha_block__moe_arch_mod__prompt_kernel_cs28
  v_mfma_f32_16x16x32_bf16 v[36:39], v[40:43], v[88:91], v[36:39]
  v_mfma_f32_16x16x32_bf16 v[36:39], v[44:47], v[92:95], v[36:39]
  v_mfma_f32_16x16x32_bf16 v[36:39], v[48:51], v[96:99], v[36:39]
  v_mfma_f32_16x16x32_bf16 v[36:39], v[52:55], v[100:103], v[36:39]
sequential_preLN__mha_block__moe_arch_mod__prompt_kernel_cs28:
  s_waitcnt lgkmcnt(4)
  v_mfma_f32_16x16x32_bf16 v[0:3], v[72:75], v[56:59], v[0:3]
  ds_read_b128 v[64:67], v136 offset:16384
  ds_read_b64_tr_b16 v[88:89], v106 offset:36864
  v_mfma_f32_16x16x32_bf16 v[4:7], v[72:75], v[60:63], v[4:7]
  ds_read_b64_tr_b16 v[90:91], v106 offset:37376
  ds_read_b128 v[68:71], v137 offset:16384
  v_mfma_f32_16x16x32_bf16 v[8:11], v[76:79], v[56:59], v[8:11]
  ds_read_b64_tr_b16 v[92:93], v107 offset:36864
  ds_read_b64_tr_b16 v[94:95], v107 offset:37376
  v_mfma_f32_16x16x32_bf16 v[12:15], v[76:79], v[60:63], v[12:15]
  ds_read_b64_tr_b16 v[96:97], v108 offset:36864
  ds_read_b64_tr_b16 v[98:99], v108 offset:37376
  v_mfma_f32_16x16x32_bf16 v[32:35], v[56:59], v[56:59], v[32:35]
  ds_read_b64_tr_b16 v[100:101], v109 offset:36864
  ds_read_b64_tr_b16 v[102:103], v109 offset:37376
  v_mfma_f32_16x16x32_bf16 v[132:135], v[40:43], v[56:59], v[132:135]
  s_waitcnt lgkmcnt(10)
  v_mfma_f32_16x16x32_bf16 v[16:19], v[80:83], v[56:59], v[16:19]
  v_mfma_f32_16x16x32_bf16 v[20:23], v[80:83], v[60:63], v[20:23]
  v_mfma_f32_16x16x32_bf16 v[24:27], v[84:87], v[56:59], v[24:27]
  v_mfma_f32_16x16x32_bf16 v[28:31], v[84:87], v[60:63], v[28:31]
  s_cmp_eq_u32 s28, 2
  s_cbranch_scc0 sequential_preLN__mha_block__moe_arch_mod__prompt_kernel_cs29
  v_mfma_f32_16x16x32_bf16 v[36:39], v[40:43], v[72:75], v[36:39]
  v_mfma_f32_16x16x32_bf16 v[36:39], v[44:47], v[76:79], v[36:39]
  v_mfma_f32_16x16x32_bf16 v[36:39], v[48:51], v[80:83], v[36:39]
  v_mfma_f32_16x16x32_bf16 v[36:39], v[52:55], v[84:87], v[36:39]
sequential_preLN__mha_block__moe_arch_mod__prompt_kernel_cs29:
  s_waitcnt lgkmcnt(0)
  v_mfma_f32_16x16x32_bf16 v[32:35], v[64:67], v[64:67], v[32:35]
  v_mfma_f32_16x16x32_bf16 v[132:135], v[40:43], v[64:67], v[132:135]
  s_cmp_eq_u32 s28, 3
  s_cbranch_scc0 sequential_preLN__mha_block__moe_arch_mod__prompt_kernel_cs30
  v_mfma_f32_16x16x32_bf16 v[36:39], v[40:43], v[88:91], v[36:39]
  v_mfma_f32_16x16x32_bf16 v[36:39], v[44:47], v[92:95], v[36:39]
  v_mfma_f32_16x16x32_bf16 v[36:39], v[48:51], v[96:99], v[36:39]
  v_mfma_f32_16x16x32_bf16 v[36:39], v[52:55], v[100:103], v[36:39]
sequential_preLN__mha_block__moe_arch_mod__prompt_kernel_cs30:
  v_mfma_f32_16x16x32_bf16 v[0:3], v[88:91], v[64:67], v[0:3]
  v_mfma_f32_16x16x32_bf16 v[4:7], v[88:91], v[68:71], v[4:7]
  v_mfma_f32_16x16x32_bf16 v[8:11], v[92:95], v[64:67], v[8:11]
  v_mfma_f32_16x16x32_bf16 v[12:15], v[92:95], v[68:71], v[12:15]
  v_mfma_f32_16x16x32_bf16 v[16:19], v[96:99], v[64:67], v[16:19]
  v_mfma_f32_16x16x32_bf16 v[20:23], v[96:99], v[68:71], v[20:23]
  v_mfma_f32_16x16x32_bf16 v[24:27], v[100:103], v[64:67], v[24:27]
  v_mfma_f32_16x16x32_bf16 v[28:31], v[100:103], v[68:71], v[28:31]
  v_cndmask_b32 v56, v32, v33, s[50:51]
  v_cndmask_b32 v56, v56, v34, s[52:53]
  v_cndmask_b32 v56, v56, v35, s[54:55]
  s_mov_b64 exec, 0xffff
  ds_write_b32 v118, v132
  ds_write_b32 v120, v36 offset:1024
  ds_write_b32 v120, v37 offset:1280
  ds_write_b32 v120, v38 offset:1536
  ds_write_b32 v120, v39 offset:1792
  s_mov_b32 exec_lo, 0x00f0000f
  s_mov_b32 exec_hi, 0xf0000f00
  ds_write_b32 v118, v56 offset:512
  s_mov_b64 exec, -1
  s_waitcnt lgkmcnt(0)
  s_barrier
  ds_read_b128 v[72:75], v121 offset:1024
  ds_read2_b32 v[60:61], v118 offset0:0 offset1:128
  ds_read2_b32 v[64:65], v122 offset0:0 offset1:128
  s_mov_b32 s3, 0x3acccccd
  s_mov_b32 s11, 0x07060302
  s_waitcnt lgkmcnt(2)
  v_add_f32 v72, v72, v73
  v_add_f32 v74, v74, v75
  v_add_f32 v72, v72, v74
  v_and_b32 v73, 0xffff0000, v72
  v_sub_f32 v73, v72, v73
  v_and_b32 v74, 0xffff0000, v73
  v_sub_f32 v74, v73, v74
  v_perm_b32 v76, v73, v72, s11
  v_cvt_pk_bf16_f32 v77, v74, 0
  s_waitcnt lgkmcnt(0)
  v_mul_f32 v60, s3, v60
  v_mul_f32 v64, s3, v64
  v_mul_f32 v61, s3, v61
  v_mul_f32 v65, s3, v65
  v_mov_b32_dpp v124, v76 quad_perm:[0,1,2,3] row_mask:0x1 bank_mask:0xf
  v_mov_b32_dpp v125, v77 quad_perm:[0,1,2,3] row_mask:0x1 bank_mask:0xf
  v_mov_b32_dpp v126, v76 quad_perm:[0,1,2,3] row_mask:0x2 bank_mask:0xf
  v_mov_b32_dpp v127, v77 quad_perm:[0,1,2,3] row_mask:0x2 bank_mask:0xf
  v_mov_b32_dpp v128, v76 quad_perm:[0,1,2,3] row_mask:0x4 bank_mask:0xf
  v_mov_b32_dpp v129, v77 quad_perm:[0,1,2,3] row_mask:0x4 bank_mask:0xf
  v_mov_b32_dpp v130, v76 quad_perm:[0,1,2,3] row_mask:0x8 bank_mask:0xf
  v_mov_b32_dpp v131, v77 quad_perm:[0,1,2,3] row_mask:0x8 bank_mask:0xf
  v_cvt_pk_bf16_f32 v62, -v60, -v60
  v_cvt_pk_bf16_f32 v66, -v64, -v64
  v_fma_f32 v61, -v60, v60, v61
  v_fma_f32 v65, -v64, v64, v65
  v_and_b32 v63, 0xffff, v62
  v_and_b32 v67, 0xffff, v66
  v_max_f32 v61, 0, v61
  v_max_f32 v65, 0, v65
  v_mfma_f32_16x16x16_bf16 v[0:3], v[124:125], v[62:63], v[0:3]
  v_cvt_pk_bf16_f32 v61, v61, v61
  v_cvt_pk_bf16_f32 v65, v65, v65
  v_mfma_f32_16x16x16_bf16 v[4:7], v[124:125], v[66:67], v[4:7]
  v_and_b32 v61, 0xffff0000, v61
  v_and_b32 v65, 0xffff0000, v65
  v_mfma_f32_16x16x16_bf16 v[8:11], v[126:127], v[62:63], v[8:11]
  v_add_f32 v61, 0x3727c5ac, v61
  v_add_f32 v65, 0x3727c5ac, v65
  v_mfma_f32_16x16x16_bf16 v[12:15], v[126:127], v[66:67], v[12:15]
  v_cvt_pk_bf16_f32 v61, v61, v61
  v_cvt_pk_bf16_f32 v65, v65, v65
  v_mfma_f32_16x16x16_bf16 v[16:19], v[128:129], v[62:63], v[16:19]
  v_and_b32 v61, 0xffff0000, v61
  v_and_b32 v65, 0xffff0000, v65
  v_mfma_f32_16x16x16_bf16 v[20:23], v[128:129], v[66:67], v[20:23]
  v_sqrt_f32 v61, v61
  v_sqrt_f32 v65, v65
  v_mfma_f32_16x16x16_bf16 v[24:27], v[130:131], v[62:63], v[24:27]
  v_cvt_pk_bf16_f32 v61, v61, v61
  v_cvt_pk_bf16_f32 v65, v65, v65
  v_mfma_f32_16x16x16_bf16 v[28:31], v[130:131], v[66:67], v[28:31]
  v_and_b32 v61, 0xffff0000, v61
  v_and_b32 v65, 0xffff0000, v65
  v_rcp_f32 v61, v61
  v_rcp_f32 v65, v65
  v_mul_f32 v61, s39, v61
  v_mul_f32 v65, s39, v65
  s_cmp_eq_u32 s101, 0
  s_cselect_b32 s22, s22, 0
  v_mul_f32 v0, v61, v0
  v_mul_f32 v1, v61, v1
  v_mul_f32 v2, v61, v2
  v_mul_f32 v3, v61, v3
  v_mul_f32 v4, v65, v4
  v_mul_f32 v5, v65, v5
  v_mul_f32 v6, v65, v6
  v_mul_f32 v7, v65, v7
  v_cvt_pk_bf16_f32 v190, v0, v1
  v_cvt_pk_bf16_f32 v191, v2, v3
  v_cvt_pk_bf16_f32 v192, v4, v5
  v_cvt_pk_bf16_f32 v193, v6, v7
  v_mul_f32 v8, v61, v8
  v_mul_f32 v9, v61, v9
  v_mul_f32 v10, v61, v10
  v_mul_f32 v11, v61, v11
  v_mul_f32 v12, v65, v12
  v_mul_f32 v13, v65, v13
  v_mul_f32 v14, v65, v14
  v_mul_f32 v15, v65, v15
  v_cvt_pk_bf16_f32 v194, v8, v9
  v_cvt_pk_bf16_f32 v195, v10, v11
  v_cvt_pk_bf16_f32 v196, v12, v13
  v_cvt_pk_bf16_f32 v197, v14, v15
  v_permlane16_swap_b32 v190, v192
  v_permlane16_swap_b32 v191, v193
  s_mov_b64 exec, s[14:15]
  buffer_store_dwordx4 v[190:193], v208, s[20:23], 0 offen sc1
  s_not_b64 exec, exec
  s_cbranch_execz sequential_preLN__mha_block__moe_arch_mod__prompt_kernel_nt31
  buffer_store_dwordx2 v[190:191], v208, s[20:23], 0 offen sc1
  buffer_store_dwordx2 v[192:193], v208, s[20:23], s74 offen sc1
sequential_preLN__mha_block__moe_arch_mod__prompt_kernel_nt31:
  s_mov_b64 exec, -1
  v_mul_f32 v16, v61, v16
  v_mul_f32 v17, v61, v17
  v_mul_f32 v18, v61, v18
  v_mul_f32 v19, v61, v19
  v_mul_f32 v20, v65, v20
  v_mul_f32 v21, v65, v21
  v_mul_f32 v22, v65, v22
  v_mul_f32 v23, v65, v23
  v_cvt_pk_bf16_f32 v198, v16, v17
  v_cvt_pk_bf16_f32 v199, v18, v19
  v_cvt_pk_bf16_f32 v200, v20, v21
  v_cvt_pk_bf16_f32 v201, v22, v23
  v_permlane16_swap_b32 v194, v196
  v_permlane16_swap_b32 v195, v197
  s_mov_b64 exec, s[18:19]
  buffer_store_dwordx4 v[194:197], v209, s[20:23], 0 offen sc1
  s_not_b64 exec, exec
  s_cbranch_execz sequential_preLN__mha_block__moe_arch_mod__prompt_kernel_nt32
  buffer_store_dwordx2 v[194:195], v209, s[20:23], 0 offen sc1
  buffer_store_dwordx2 v[196:197], v209, s[20:23], s74 offen sc1
sequential_preLN__mha_block__moe_arch_mod__prompt_kernel_nt32:
  s_mov_b64 exec, -1
  v_mul_f32 v24, v61, v24
  v_mul_f32 v25, v61, v25
  v_mul_f32 v26, v61, v26
  v_mul_f32 v27, v61, v27
  v_mul_f32 v28, v65, v28
  v_mul_f32 v29, v65, v29
  v_mul_f32 v30, v65, v30
  v_mul_f32 v31, v65, v31
  v_cvt_pk_bf16_f32 v202, v24, v25
  v_cvt_pk_bf16_f32 v203, v26, v27
  v_cvt_pk_bf16_f32 v204, v28, v29
  v_cvt_pk_bf16_f32 v205, v30, v31
  v_permlane16_swap_b32 v198, v200
  v_permlane16_swap_b32 v199, v201
  s_mov_b64 exec, s[40:41]
  buffer_store_dwordx4 v[198:201], v210, s[20:23], 0 offen sc1
  s_not_b64 exec, exec
  s_cbranch_execz sequential_preLN__mha_block__moe_arch_mod__prompt_kernel_nt33
  buffer_store_dwordx2 v[198:199], v210, s[20:23], 0 offen sc1
  buffer_store_dwordx2 v[200:201], v210, s[20:23], s74 offen sc1
sequential_preLN__mha_block__moe_arch_mod__prompt_kernel_nt33:
  s_mov_b64 exec, -1
  v_permlane16_swap_b32 v202, v204
  v_permlane16_swap_b32 v203, v205
  s_mov_b64 exec, s[46:47]
  buffer_store_dwordx4 v[202:205], v211, s[20:23], 0 offen sc1
  s_not_b64 exec, exec
  s_cbranch_execz sequential_preLN__mha_block__moe_arch_mod__prompt_kernel_nt34
  buffer_store_dwordx2 v[202:203], v211, s[20:23], 0 offen sc1
  buffer_store_dwordx2 v[204:205], v211, s[20:23], s74 offen sc1
sequential_preLN__mha_block__moe_arch_mod__prompt_kernel_nt34:
  s_mov_b64 exec, -1
  s_mov_b32 s22, 268435456
  s_branch sequential_preLN__mha_block__moe_arch_mod__prompt_kernel_join6
sequential_preLN__mha_block__moe_arch_mod__prompt_kernel_vpath5:
  s_sub_u32 s10, s33, 10
  s_lshl_b32 s10, s10, 7
  s_lshl_b32 s11, s27, 6
  s_add_u32 s10, s10, s11
  v_add_u32 v7, s10, v1
  v_xor_b32 v3, s27, v157
  v_mul_u32_u24 v3, 640, v3
  v_lshl_add_u32 v3, v6, 4, v3
  s_mul_i32 s10, s38, 2560
  s_add_u32 s10, s10, 2622720
  v_add_u32 v3, s10, v3
  s_mov_b32 s11, 163200
  v_mul_u32_u24 v4, 3277, v7
  v_lshrrev_b32 v4, 16, v4
  v_lshl_add_u32 v5, v7, 5, v3
  v_mad_u32_u24 v208, v4, s11, v5
  v_add_u32 v7, 16, v7
  v_mul_u32_u24 v4, 3277, v7
  v_lshrrev_b32 v4, 16, v4
  v_lshl_add_u32 v5, v7, 5, v3
  v_mad_u32_u24 v209, v4, s11, v5
  v_add_u32 v7, 16, v7
  v_mul_u32_u24 v4, 3277, v7
  v_lshrrev_b32 v4, 16, v4
  v_lshl_add_u32 v5, v7, 5, v3
  v_mad_u32_u24 v210, v4, s11, v5
  v_add_u32 v7, 16, v7
  v_mul_u32_u24 v4, 3277, v7
  v_lshrrev_b32 v4, 16, v4
  v_lshl_add_u32 v5, v7, 5, v3
  v_mad_u32_u24 v211, v4, s11, v5
  v_add_u32 v7, 16, v7
  s_cmp_ge_u32 s29, 8
  s_cselect_b32 s101, 2, 0
  v_mov_b32 v212, v208
  v_mov_b32 v213, v208
  v_mov_b32 v214, v208
  v_mov_b32 v215, v208
  v_mov_b32 v216, v208
  v_mov_b32 v217, v208
  v_mov_b32 v218, v208
  v_mov_b32 v219, v208
  s_waitcnt vmcnt(4) lgkmcnt(0)
  s_barrier
  ds_read_b128 v[56:59], v104 offset:0
  ds_read_b64_tr_b16 v[72:73], v106 offset:0
  ds_read_b64_tr_b16 v[74:75], v106 offset:512
  ds_read_b128 v[60:63], v105 offset:0
  ds_read_b64_tr_b16 v[76:77], v107 offset:0
  ds_read_b64_tr_b16 v[78:79], v107 offset:512
  ds_read_b64_tr_b16 v[80:81], v108 offset:0
  ds_read_b64_tr_b16 v[82:83], v108 offset:512
  ds_read_b64_tr_b16 v[84:85], v109 offset:0
  ds_read_b64_tr_b16 v[86:87], v109 offset:512
  s_waitcnt lgkmcnt(4)
  v_mfma_f32_16x16x32_bf16 v[0:3], v[56:59], v[72:75], 0
  ds_read_b128 v[64:67], v136 offset:0
  ds_read_b64_tr_b16 v[88:89], v106 offset:4096
  v_mfma_f32_16x16x32_bf16 v[4:7], v[60:63], v[72:75], 0
  ds_read_b64_tr_b16 v[90:91], v106 offset:4608
  ds_read_b128 v[68:71], v137 offset:0
  v_mfma_f32_16x16x32_bf16 v[8:11], v[56:59], v[76:79], 0
  ds_read_b64_tr_b16 v[92:93], v107 offset:4096
  ds_read_b64_tr_b16 v[94:95], v107 offset:4608
  v_mfma_f32_16x16x32_bf16 v[12:15], v[60:63], v[76:79], 0
  ds_read_b64_tr_b16 v[96:97], v108 offset:4096
  ds_read_b64_tr_b16 v[98:99], v108 offset:4608
  v_mfma_f32_16x16x32_bf16 v[32:35], v[56:59], v[56:59], 0
  ds_read_b64_tr_b16 v[100:101], v109 offset:4096
  ds_read_b64_tr_b16 v[102:103], v109 offset:4608
  v_mfma_f32_16x16x32_bf16 v[132:135], v[40:43], v[56:59], 0
  s_waitcnt lgkmcnt(10)
  s_lshl_b32 s32, s34, 7
  s_add_u32 s32, s32, s36
  s_mul_i32 s35, s34, 245760
  s_add_u32 s35, s35, s37
  s_add_u32 m0, s30, 8192
  s_add_u32 s34, s34, 1
  buffer_load_dwordx4 v110, s[60:63], s32 offen lds
  v_mfma_f32_16x16x32_bf16 v[16:19], v[56:59], v[80:83], 0
  v_mfma_f32_16x16x32_bf16 v[20:23], v[60:63], v[80:83], 0
  s_add_u32 m0, s31, 16384
  s_cmp_eq_u32 s34, 10
  buffer_load_dwordx4 v112, s[68:71], s35 offen lds
  s_cselect_b32 s34, 0, s34
  v_mfma_f32_16x16x32_bf16 v[24:27], v[56:59], v[84:87], 0
  v_mfma_f32_16x16x32_bf16 v[28:31], v[60:63], v[84:87], 0
  s_add_u32 m0, s30, 10240
  s_nop 0
  buffer_load_dwordx4 v111, s[60:63], s32 offen lds
  s_cmp_eq_u32 s28, 0
  s_cbranch_scc0 sequential_preLN__mha_block__moe_arch_mod__prompt_kernel_cs35
  v_mfma_f32_16x16x32_bf16 v[36:39], v[40:43], v[72:75], v[36:39]
  v_mfma_f32_16x16x32_bf16 v[36:39], v[44:47], v[76:79], v[36:39]
  v_mfma_f32_16x16x32_bf16 v[36:39], v[48:51], v[80:83], v[36:39]
  v_mfma_f32_16x16x32_bf16 v[36:39], v[52:55], v[84:87], v[36:39]
sequential_preLN__mha_block__moe_arch_mod__prompt_kernel_cs35:
  s_waitcnt vmcnt(3) lgkmcnt(0)
  s_barrier
  v_mfma_f32_16x16x32_bf16 v[0:3], v[64:67], v[88:91], v[0:3]
  ds_read_b128 v[56:59], v104 offset:4096
  ds_read_b64_tr_b16 v[72:73], v106 offset:8192
  v_mfma_f32_16x16x32_bf16 v[4:7], v[68:71], v[88:91], v[4:7]
  ds_read_b64_tr_b16 v[74:75], v106 offset:8704
  ds_read_b128 v[60:63], v105 offset:4096
  v_mfma_f32_16x16x32_bf16 v[8:11], v[64:67], v[92:95], v[8:11]
  ds_read_b64_tr_b16 v[76:77], v107 offset:8192
  ds_read_b64_tr_b16 v[78:79], v107 offset:8704
  v_mfma_f32_16x16x32_bf16 v[12:15], v[68:71], v[92:95], v[12:15]
  ds_read_b64_tr_b16 v[80:81], v108 offset:8192
  ds_read_b64_tr_b16 v[82:83], v108 offset:8704
  v_mfma_f32_16x16x32_bf16 v[32:35], v[64:67], v[64:67], v[32:35]
  ds_read_b64_tr_b16 v[84:85], v109 offset:8192
  ds_read_b64_tr_b16 v[86:87], v109 offset:8704
  v_mfma_f32_16x16x32_bf16 v[132:135], v[40:43], v[64:67], v[132:135]
  s_add_u32 m0, s31, 57216
  s_nop 0
  buffer_load_dwordx4 v112, s[68:71], s35 offen offset:128 lds
  v_mfma_f32_16x16x32_bf16 v[16:19], v[64:67], v[96:99], v[16:19]
  v_mfma_f32_16x16x32_bf16 v[20:23], v[68:71], v[96:99], v[20:23]
  s_lshl_b32 s32, s34, 7
  s_add_u32 s32, s32, s36
  s_mul_i32 s35, s34, 245760
  s_add_u32 s35, s35, s37
  s_add_u32 m0, s30, 12288
  s_add_u32 s34, s34, 1
  buffer_load_dwordx4 v110, s[60:63], s32 offen lds
  v_mfma_f32_16x16x32_bf16 v[24:27], v[64:67], v[100:103], v[24:27]
  v_mfma_f32_16x16x32_bf16 v[28:31], v[68:71], v[100:103], v[28:31]
  s_add_u32 m0, s31, 24576
  s_cmp_eq_u32 s34, 10
  buffer_load_dwordx4 v112, s[68:71], s35 offen lds
  s_cselect_b32 s34, 0, s34
  s_cmp_eq_u32 s28, 1
  s_cbranch_scc0 sequential_preLN__mha_block__moe_arch_mod__prompt_kernel_cs36
  v_mfma_f32_16x16x32_bf16 v[36:39], v[40:43], v[88:91], v[36:39]
  v_mfma_f32_16x16x32_bf16 v[36:39], v[44:47], v[92:95], v[36:39]
  v_mfma_f32_16x16x32_bf16 v[36:39], v[48:51], v[96:99], v[36:39]
  v_mfma_f32_16x16x32_bf16 v[36:39], v[52:55], v[100:103], v[36:39]
sequential_preLN__mha_block__moe_arch_mod__prompt_kernel_cs36:
  s_waitcnt lgkmcnt(4)
  v_mfma_f32_16x16x32_bf16 v[0:3], v[56:59], v[72:75], v[0:3]
  ds_read_b128 v[64:67], v136 offset:4096
  ds_read_b64_tr_b16 v[88:89], v106 offset:12288
  v_mfma_f32_16x16x32_bf16 v[4:7], v[60:63], v[72:75], v[4:7]
  ds_read_b64_tr_b16 v[90:91], v106 offset:12800
  ds_read_b128 v[68:71], v137 offset:4096
  v_mfma_f32_16x16x32_bf16 v[8:11], v[56:59], v[76:79], v[8:11]
  ds_read_b64_tr_b16 v[92:93], v107 offset:12288
  ds_read_b64_tr_b16 v[94:95], v107 offset:12800
  v_mfma_f32_16x16x32_bf16 v[12:15], v[60:63], v[76:79], v[12:15]
  ds_read_b64_tr_b16 v[96:97], v108 offset:12288
  ds_read_b64_tr_b16 v[98:99], v108 offset:12800
  v_mfma_f32_16x16x32_bf16 v[32:35], v[56:59], v[56:59], v[32:35]
  ds_read_b64_tr_b16 v[100:101], v109 offset:12288
  ds_read_b64_tr_b16 v[102:103], v109 offset:12800
  v_mfma_f32_16x16x32_bf16 v[132:135], v[40:43], v[56:59], v[132:135]
  s_waitcnt lgkmcnt(10)
  s_add_u32 m0, s30, 14336
  s_nop 0
  buffer_load_dwordx4 v111, s[60:63], s32 offen lds
  v_mfma_f32_16x16x32_bf16 v[16:19], v[56:59], v[80:83], v[16:19]
  v_mfma_f32_16x16x32_bf16 v[20:23], v[60:63], v[80:83], v[20:23]
  s_add_u32 m0, s31, 65408
  s_nop 0
  buffer_load_dwordx4 v112, s[68:71], s35 offen offset:128 lds
  v_mfma_f32_16x16x32_bf16 v[24:27], v[56:59], v[84:87], v[24:27]
  v_mfma_f32_16x16x32_bf16 v[28:31], v[60:63], v[84:87], v[28:31]
  s_lshl_b32 s32, s34, 7
  s_add_u32 s32, s32, s36
  s_mul_i32 s35, s34, 245760
  s_add_u32 s35, s35, s37
  s_add_u32 m0, s30, 16384
  s_add_u32 s34, s34, 1
  buffer_load_dwordx4 v110, s[60:63], s32 offen lds
  s_cmp_eq_u32 s28, 2
  s_cbranch_scc0 sequential_preLN__mha_block__moe_arch_mod__prompt_kernel_cs37
  v_mfma_f32_16x16x32_bf16 v[36:39], v[40:43], v[72:75], v[36:39]
  v_mfma_f32_16x16x32_bf16 v[36:39], v[44:47], v[76:79], v[36:39]
  v_mfma_f32_16x16x32_bf16 v[36:39], v[48:51], v[80:83], v[36:39]
  v_mfma_f32_16x16x32_bf16 v[36:39], v[52:55], v[84:87], v[36:39]
sequential_preLN__mha_block__moe_arch_mod__prompt_kernel_cs37:
  s_waitcnt vmcnt(5) lgkmcnt(0)
  s_barrier
  v_mfma_f32_16x16x32_bf16 v[0:3], v[64:67], v[88:91], v[0:3]
  ds_read_b128 v[56:59], v104 offset:8192
  ds_read_b64_tr_b16 v[72:73], v106 offset:16384
  v_mfma_f32_16x16x32_bf16 v[4:7], v[68:71], v[88:91], v[4:7]
  ds_read_b64_tr_b16 v[74:75], v106 offset:16896
  ds_read_b128 v[60:63], v105 offset:8192
  v_mfma_f32_16x16x32_bf16 v[8:11], v[64:67], v[92:95], v[8:11]
  ds_read_b64_tr_b16 v[76:77], v107 offset:16384
  ds_read_b64_tr_b16 v[78:79], v107 offset:16896
  v_mfma_f32_16x16x32_bf16 v[12:15], v[68:71], v[92:95], v[12:15]
  ds_read_b64_tr_b16 v[80:81], v108 offset:16384
  ds_read_b64_tr_b16 v[82:83], v108 offset:16896
  v_mfma_f32_16x16x32_bf16 v[32:35], v[64:67], v[64:67], v[32:35]
  ds_read_b64_tr_b16 v[84:85], v109 offset:16384
  ds_read_b64_tr_b16 v[86:87], v109 offset:16896
  v_mfma_f32_16x16x32_bf16 v[132:135], v[40:43], v[64:67], v[132:135]
  s_add_u32 m0, s31, 32768
  s_cmp_eq_u32 s34, 10
  buffer_load_dwordx4 v112, s[68:71], s35 offen lds
  s_cselect_b32 s34, 0, s34
  v_mfma_f32_16x16x32_bf16 v[16:19], v[64:67], v[96:99], v[16:19]
  v_mfma_f32_16x16x32_bf16 v[20:23], v[68:71], v[96:99], v[20:23]
  s_add_u32 m0, s30, 18432
  s_nop 0
  buffer_load_dwordx4 v111, s[60:63], s32 offen lds
  v_mfma_f32_16x16x32_bf16 v[24:27], v[64:67], v[100:103], v[24:27]
  v_mfma_f32_16x16x32_bf16 v[28:31], v[68:71], v[100:103], v[28:31]
  s_add_u32 m0, s31, 73600
  s_nop 0
  buffer_load_dwordx4 v112, s[68:71], s35 offen offset:128 lds
  s_cmp_eq_u32 s28, 3
  s_cbranch_scc0 sequential_preLN__mha_block__moe_arch_mod__prompt_kernel_cs38
  v_mfma_f32_16x16x32_bf16 v[36:39], v[40:43], v[88:91], v[36:39]
  v_mfma_f32_16x16x32_bf16 v[36:39], v[44:47], v[92:95], v[36:39]
  v_mfma_f32_16x16x32_bf16 v[36:39], v[48:51], v[96:99], v[36:39]
  v_mfma_f32_16x16x32_bf16 v[36:39], v[52:55], v[100:103], v[36:39]
sequential_preLN__mha_block__moe_arch_mod__prompt_kernel_cs38:
  s_waitcnt lgkmcnt(4)
  v_mfma_f32_16x16x32_bf16 v[0:3], v[56:59], v[72:75], v[0:3]
  ds_read_b128 v[64:67], v136 offset:8192
  ds_read_b64_tr_b16 v[88:89], v106 offset:20480
  v_mfma_f32_16x16x32_bf16 v[4:7], v[60:63], v[72:75], v[4:7]
  ds_read_b64_tr_b16 v[90:91], v106 offset:20992
  ds_read_b128 v[68:71], v137 offset:8192
  v_mfma_f32_16x16x32_bf16 v[8:11], v[56:59], v[76:79], v[8:11]
  ds_read_b64_tr_b16 v[92:93], v107 offset:20480
  ds_read_b64_tr_b16 v[94:95], v107 offset:20992
  v_mfma_f32_16x16x32_bf16 v[12:15], v[60:63], v[76:79], v[12:15]
  ds_read_b64_tr_b16 v[96:97], v108 offset:20480
  ds_read_b64_tr_b16 v[98:99], v108 offset:20992
  v_mfma_f32_16x16x32_bf16 v[32:35], v[56:59], v[56:59], v[32:35]
  ds_read_b64_tr_b16 v[100:101], v109 offset:20480
  ds_read_b64_tr_b16 v[102:103], v109 offset:20992
  v_mfma_f32_16x16x32_bf16 v[132:135], v[40:43], v[56:59], v[132:135]
  s_waitcnt lgkmcnt(10)
  s_lshl_b32 s32, s34, 7
  s_add_u32 s32, s32, s36
  s_mul_i32 s35, s34, 245760
  s_add_u32 s35, s35, s37
  s_add_u32 m0, s30, 0
  s_add_u32 s34, s34, 1
  buffer_load_dwordx4 v110, s[60:63], s32 offen lds
  v_mfma_f32_16x16x32_bf16 v[16:19], v[56:59], v[80:83], v[16:19]
  v_mfma_f32_16x16x32_bf16 v[20:23], v[60:63], v[80:83], v[20:23]
  s_add_u32 m0, s31, 0
  s_cmp_eq_u32 s34, 10
  buffer_load_dwordx4 v112, s[68:71], s35 offen lds
  s_cselect_b32 s34, 0, s34
  v_mfma_f32_16x16x32_bf16 v[24:27], v[56:59], v[84:87], v[24:27]
  v_mfma_f32_16x16x32_bf16 v[28:31], v[60:63], v[84:87], v[28:31]
  s_add_u32 m0, s30, 2048
  s_nop 0
  buffer_load_dwordx4 v111, s[60:63], s32 offen lds
  s_cmp_eq_u32 s28, 0
  s_cbranch_scc0 sequential_preLN__mha_block__moe_arch_mod__prompt_kernel_cs39
  v_mfma_f32_16x16x32_bf16 v[36:39], v[40:43], v[72:75], v[36:39]
  v_mfma_f32_16x16x32_bf16 v[36:39], v[44:47], v[76:79], v[36:39]
  v_mfma_f32_16x16x32_bf16 v[36:39], v[48:51], v[80:83], v[36:39]
  v_mfma_f32_16x16x32_bf16 v[36:39], v[52:55], v[84:87], v[36:39]
sequential_preLN__mha_block__moe_arch_mod__prompt_kernel_cs39:
  s_waitcnt vmcnt(7) lgkmcnt(0)
  s_barrier
  v_mfma_f32_16x16x32_bf16 v[0:3], v[64:67], v[88:91], v[0:3]
  ds_read_b128 v[56:59], v104 offset:12288
  ds_read_b64_tr_b16 v[72:73], v106 offset:24576
  v_mfma_f32_16x16x32_bf16 v[4:7], v[68:71], v[88:91], v[4:7]
  ds_read_b64_tr_b16 v[74:75], v106 offset:25088
  ds_read_b128 v[60:63], v105 offset:12288
  v_mfma_f32_16x16x32_bf16 v[8:11], v[64:67], v[92:95], v[8:11]
  ds_read_b64_tr_b16 v[76:77], v107 offset:24576
  ds_read_b64_tr_b16 v[78:79], v107 offset:25088
  v_mfma_f32_16x16x32_bf16 v[12:15], v[68:71], v[92:95], v[12:15]
  ds_read_b64_tr_b16 v[80:81], v108 offset:24576
  ds_read_b64_tr_b16 v[82:83], v108 offset:25088
  v_mfma_f32_16x16x32_bf16 v[32:35], v[64:67], v[64:67], v[32:35]
  ds_read_b64_tr_b16 v[84:85], v109 offset:24576
  ds_read_b64_tr_b16 v[86:87], v109 offset:25088
  v_mfma_f32_16x16x32_bf16 v[132:135], v[40:43], v[64:67], v[132:135]
  s_add_u32 m0, s31, 40832
  s_nop 0
  buffer_load_dwordx4 v112, s[68:71], s35 offen offset:128 lds
  v_mfma_f32_16x16x32_bf16 v[16:19], v[64:67], v[96:99], v[16:19]
  v_mfma_f32_16x16x32_bf16 v[20:23], v[68:71], v[96:99], v[20:23]
  s_lshl_b32 s32, s34, 7
  s_add_u32 s32, s32, s36
  s_mul_i32 s35, s34, 245760
  s_add_u32 s35, s35, s37
  s_add_u32 m0, s30, 4096
  s_add_u32 s34, s34, 1
  buffer_load_dwordx4 v110, s[60:63], s32 offen lds
  v_mfma_f32_16x16x32_bf16 v[24:27], v[64:67], v[100:103], v[24:27]
  v_mfma_f32_16x16x32_bf16 v[28:31], v[68:71], v[100:103], v[28:31]
  s_add_u32 m0, s31, 8192
  s_cmp_eq_u32 s34, 10
  buffer_load_dwordx4 v112, s[68:71], s35 offen lds
  s_cselect_b32 s34, 0, s34
  s_cmp_eq_u32 s28, 1
  s_cbranch_scc0 sequential_preLN__mha_block__moe_arch_mod__prompt_kernel_cs40
  v_mfma_f32_16x16x32_bf16 v[36:39], v[40:43], v[88:91], v[36:39]
  v_mfma_f32_16x16x32_bf16 v[36:39], v[44:47], v[92:95], v[36:39]
  v_mfma_f32_16x16x32_bf16 v[36:39], v[48:51], v[96:99], v[36:39]
  v_mfma_f32_16x16x32_bf16 v[36:39], v[52:55], v[100:103], v[36:39]
sequential_preLN__mha_block__moe_arch_mod__prompt_kernel_cs40:
  s_waitcnt lgkmcnt(4)
  s_cmp_eq_u32 s26, 0
  s_cbranch_scc0 sequential_preLN__mha_block__moe_arch_mod__prompt_kernel_dl41
  buffer_load_dword v161, v162, s[56:59], 0 offen sc1
sequential_preLN__mha_block__moe_arch_mod__prompt_kernel_dl41:
  v_mfma_f32_16x16x32_bf16 v[0:3], v[56:59], v[72:75], v[0:3]
  ds_read_b128 v[64:67], v136 offset:12288
  ds_read_b64_tr_b16 v[88:89], v106 offset:28672
  v_mfma_f32_16x16x32_bf16 v[4:7], v[60:63], v[72:75], v[4:7]
  ds_read_b64_tr_b16 v[90:91], v106 offset:29184
  ds_read_b128 v[68:71], v137 offset:12288
  v_mfma_f32_16x16x32_bf16 v[8:11], v[56:59], v[76:79], v[8:11]
  ds_read_b64_tr_b16 v[92:93], v107 offset:28672
  ds_read_b64_tr_b16 v[94:95], v107 offset:29184
  v_mfma_f32_16x16x32_bf16 v[12:15], v[60:63], v[76:79], v[12:15]
  ds_read_b64_tr_b16 v[96:97], v108 offset:28672
  ds_read_b64_tr_b16 v[98:99], v108 offset:29184
  v_mfma_f32_16x16x32_bf16 v[32:35], v[56:59], v[56:59], v[32:35]
  ds_read_b64_tr_b16 v[100:101], v109 offset:28672
  ds_read_b64_tr_b16 v[102:103], v109 offset:29184
  v_mfma_f32_16x16x32_bf16 v[132:135], v[40:43], v[56:59], v[132:135]
  s_waitcnt lgkmcnt(10)
  s_add_u32 m0, s30, 6144
  s_nop 0
  buffer_load_dwordx4 v111, s[60:63], s32 offen lds
  v_mfma_f32_16x16x32_bf16 v[16:19], v[56:59], v[80:83], v[16:19]
  v_mfma_f32_16x16x32_bf16 v[20:23], v[60:63], v[80:83], v[20:23]
  s_add_u32 m0, s31, 49024
  s_nop 0
  buffer_load_dwordx4 v112, s[68:71], s35 offen offset:128 lds
  v_mfma_f32_16x16x32_bf16 v[24:27], v[56:59], v[84:87], v[24:27]
  v_mfma_f32_16x16x32_bf16 v[28:31], v[60:63], v[84:87], v[28:31]
  s_lshl_b32 s32, s34, 7
  s_add_u32 s32, s32, s36
  s_mul_i32 s35, s34, 245760
  s_add_u32 s35, s35, s37
  s_add_u32 m0, s30, 8192
  s_add_u32 s34, s34, 1
  buffer_load_dwordx4 v110, s[60:63], s32 offen lds
  s_cmp_eq_u32 s28, 2
  s_cbranch_scc0 sequential_preLN__mha_block__moe_arch_mod__prompt_kernel_cs42
  v_mfma_f32_16x16x32_bf16 v[36:39], v[40:43], v[72:75], v[36:39]
  v_mfma_f32_16x16x32_bf16 v[36:39], v[44:47], v[76:79], v[36:39]
  v_mfma_f32_16x16x32_bf16 v[36:39], v[48:51], v[80:83], v[36:39]
  v_mfma_f32_16x16x32_bf16 v[36:39], v[52:55], v[84:87], v[36:39]
sequential_preLN__mha_block__moe_arch_mod__prompt_kernel_cs42:
  s_waitcnt vmcnt(9) lgkmcnt(0)
  s_barrier
  v_mfma_f32_16x16x32_bf16 v[0:3], v[64:67], v[88:91], v[0:3]
  ds_read_b128 v[56:59], v104 offset:16384
  ds_read_b64_tr_b16 v[72:73], v106 offset:32768
  v_mfma_f32_16x16x32_bf16 v[4:7], v[68:71], v[88:91], v[4:7]
  ds_read_b64_tr_b16 v[74:75], v106 offset:33280
  ds_read_b128 v[60:63], v105 offset:16384
  v_mfma_f32_16x16x32_bf16 v[8:11], v[64:67], v[92:95], v[8:11]
  ds_read_b64_tr_b16 v[76:77], v107 offset:32768
  ds_read_b64_tr_b16 v[78:79], v107 offset:33280
  v_mfma_f32_16x16x32_bf16 v[12:15], v[68:71], v[92:95], v[12:15]
  ds_read_b64_tr_b16 v[80:81], v108 offset:32768
  ds_read_b64_tr_b16 v[82:83], v108 offset:33280
  v_mfma_f32_16x16x32_bf16 v[32:35], v[64:67], v[64:67], v[32:35]
  ds_read_b64_tr_b16 v[84:85], v109 offset:32768
  ds_read_b64_tr_b16 v[86:87], v109 offset:33280
  v_mfma_f32_16x16x32_bf16 v[132:135], v[40:43], v[64:67], v[132:135]
  s_add_u32 m0, s31, 16384
  s_cmp_eq_u32 s34, 10
  buffer_load_dwordx4 v112, s[68:71], s35 offen lds
  s_cselect_b32 s34, 0, s34
  v_mfma_f32_16x16x32_bf16 v[16:19], v[64:67], v[96:99], v[16:19]
  v_mfma_f32_16x16x32_bf16 v[20:23], v[68:71], v[96:99], v[20:23]
  s_add_u32 m0, s30, 10240
  s_nop 0
  buffer_load_dwordx4 v111, s[60:63], s32 offen lds
  v_mfma_f32_16x16x32_bf16 v[24:27], v[64:67], v[100:103], v[24:27]
  v_mfma_f32_16x16x32_bf16 v[28:31], v[68:71], v[100:103], v[28:31]
  s_add_u32 m0, s31, 57216
  s_nop 0
  buffer_load_dwordx4 v112, s[68:71], s35 offen offset:128 lds
  s_cmp_eq_u32 s28, 3
  s_cbranch_scc0 sequential_preLN__mha_block__moe_arch_mod__prompt_kernel_cs43
  v_mfma_f32_16x16x32_bf16 v[36:39], v[40:43], v[88:91], v[36:39]
  v_mfma_f32_16x16x32_bf16 v[36:39], v[44:47], v[92:95], v[36:39]
  v_mfma_f32_16x16x32_bf16 v[36:39], v[48:51], v[96:99], v[36:39]
  v_mfma_f32_16x16x32_bf16 v[36:39], v[52:55], v[100:103], v[36:39]
sequential_preLN__mha_block__moe_arch_mod__prompt_kernel_cs43:
  s_waitcnt lgkmcnt(4)
  v_mfma_f32_16x16x32_bf16 v[0:3], v[56:59], v[72:75], v[0:3]
  ds_read_b128 v[64:67], v136 offset:16384
  ds_read_b64_tr_b16 v[88:89], v106 offset:36864
  v_mfma_f32_16x16x32_bf16 v[4:7], v[60:63], v[72:75], v[4:7]
  ds_read_b64_tr_b16 v[90:91], v106 offset:37376
  ds_read_b128 v[68:71], v137 offset:16384
  v_mfma_f32_16x16x32_bf16 v[8:11], v[56:59], v[76:79], v[8:11]
  ds_read_b64_tr_b16 v[92:93], v107 offset:36864
  ds_read_b64_tr_b16 v[94:95], v107 offset:37376
  v_mfma_f32_16x16x32_bf16 v[12:15], v[60:63], v[76:79], v[12:15]
  ds_read_b64_tr_b16 v[96:97], v108 offset:36864
  ds_read_b64_tr_b16 v[98:99], v108 offset:37376
  v_mfma_f32_16x16x32_bf16 v[32:35], v[56:59], v[56:59], v[32:35]
  ds_read_b64_tr_b16 v[100:101], v109 offset:36864
  ds_read_b64_tr_b16 v[102:103], v109 offset:37376
  v_mfma_f32_16x16x32_bf16 v[132:135], v[40:43], v[56:59], v[132:135]
  s_waitcnt lgkmcnt(10)
  s_lshl_b32 s32, s34, 7
  s_add_u32 s32, s32, s36
  s_mul_i32 s35, s34, 245760
  s_add_u32 s35, s35, s37
  s_add_u32 m0, s30, 12288
  s_add_u32 s34, s34, 1
  buffer_load_dwordx4 v110, s[60:63], s32 offen lds
  v_mfma_f32_16x16x32_bf16 v[16:19], v[56:59], v[80:83], v[16:19]
  v_mfma_f32_16x16x32_bf16 v[20:23], v[60:63], v[80:83], v[20:23]
  s_add_u32 m0, s31, 24576
  s_cmp_eq_u32 s34, 10
  buffer_load_dwordx4 v112, s[68:71], s35 offen lds
  s_cselect_b32 s34, 0, s34
  v_mfma_f32_16x16x32_bf16 v[24:27], v[56:59], v[84:87], v[24:27]
  v_mfma_f32_16x16x32_bf16 v[28:31], v[60:63], v[84:87], v[28:31]
  s_add_u32 m0, s30, 14336
  s_nop 0
  buffer_load_dwordx4 v111, s[60:63], s32 offen lds
  s_cmp_eq_u32 s28, 0
  s_cbranch_scc0 sequential_preLN__mha_block__moe_arch_mod__prompt_kernel_cs44
  v_mfma_f32_16x16x32_bf16 v[36:39], v[40:43], v[72:75], v[36:39]
  v_mfma_f32_16x16x32_bf16 v[36:39], v[44:47], v[76:79], v[36:39]
  v_mfma_f32_16x16x32_bf16 v[36:39], v[48:51], v[80:83], v[36:39]
  v_mfma_f32_16x16x32_bf16 v[36:39], v[52:55], v[84:87], v[36:39]
sequential_preLN__mha_block__moe_arch_mod__prompt_kernel_cs44:
  s_waitcnt vmcnt(11) lgkmcnt(0)
  s_barrier
  v_mfma_f32_16x16x32_bf16 v[0:3], v[64:67], v[88:91], v[0:3]
  ds_read_b128 v[56:59], v104 offset:0
  ds_read_b64_tr_b16 v[72:73], v106 offset:0
  v_mfma_f32_16x16x32_bf16 v[4:7], v[68:71], v[88:91], v[4:7]
  ds_read_b64_tr_b16 v[74:75], v106 offset:512
  ds_read_b128 v[60:63], v105 offset:0
  v_mfma_f32_16x16x32_bf16 v[8:11], v[64:67], v[92:95], v[8:11]
  ds_read_b64_tr_b16 v[76:77], v107 offset:0
  ds_read_b64_tr_b16 v[78:79], v107 offset:512
  v_mfma_f32_16x16x32_bf16 v[12:15], v[68:71], v[92:95], v[12:15]
  ds_read_b64_tr_b16 v[80:81], v108 offset:0
  ds_read_b64_tr_b16 v[82:83], v108 offset:512
  v_mfma_f32_16x16x32_bf16 v[32:35], v[64:67], v[64:67], v[32:35]
  ds_read_b64_tr_b16 v[84:85], v109 offset:0
  ds_read_b64_tr_b16 v[86:87], v109 offset:512
  v_mfma_f32_16x16x32_bf16 v[132:135], v[40:43], v[64:67], v[132:135]
  s_add_u32 m0, s31, 65408
  s_nop 0
  buffer_load_dwordx4 v112, s[68:71], s35 offen offset:128 lds
  v_mfma_f32_16x16x32_bf16 v[16:19], v[64:67], v[96:99], v[16:19]
  v_mfma_f32_16x16x32_bf16 v[20:23], v[68:71], v[96:99], v[20:23]
  s_lshl_b32 s32, s34, 7
  s_add_u32 s32, s32, s36
  s_mul_i32 s35, s34, 245760
  s_add_u32 s35, s35, s37
  s_add_u32 m0, s30, 16384
  s_add_u32 s34, s34, 1
  buffer_load_dwordx4 v110, s[60:63], s32 offen lds
  v_mfma_f32_16x16x32_bf16 v[24:27], v[64:67], v[100:103], v[24:27]
  v_mfma_f32_16x16x32_bf16 v[28:31], v[68:71], v[100:103], v[28:31]
  s_add_u32 m0, s31, 32768
  s_cmp_eq_u32 s34, 10
  buffer_load_dwordx4 v112, s[68:71], s35 offen lds
  s_cselect_b32 s34, 0, s34
  s_cmp_eq_u32 s28, 1
  s_cbranch_scc0 sequential_preLN__mha_block__moe_arch_mod__prompt_kernel_cs45
  v_mfma_f32_16x16x32_bf16 v[36:39], v[40:43], v[88:91], v[36:39]
  v_mfma_f32_16x16x32_bf16 v[36:39], v[44:47], v[92:95], v[36:39]
  v_mfma_f32_16x16x32_bf16 v[36:39], v[48:51], v[96:99], v[36:39]
  v_mfma_f32_16x16x32_bf16 v[36:39], v[52:55], v[100:103], v[36:39]
sequential_preLN__mha_block__moe_arch_mod__prompt_kernel_cs45:
  s_waitcnt lgkmcnt(4)
  v_mfma_f32_16x16x32_bf16 v[0:3], v[56:59], v[72:75], v[0:3]
  ds_read_b128 v[64:67], v136 offset:0
  ds_read_b64_tr_b16 v[88:89], v106 offset:4096
  v_mfma_f32_16x16x32_bf16 v[4:7], v[60:63], v[72:75], v[4:7]
  ds_read_b64_tr_b16 v[90:91], v106 offset:4608
  ds_read_b128 v[68:71], v137 offset:0
  v_mfma_f32_16x16x32_bf16 v[8:11], v[56:59], v[76:79], v[8:11]
  ds_read_b64_tr_b16 v[92:93], v107 offset:4096
  ds_read_b64_tr_b16 v[94:95], v107 offset:4608
  v_mfma_f32_16x16x32_bf16 v[12:15], v[60:63], v[76:79], v[12:15]
  ds_read_b64_tr_b16 v[96:97], v108 offset:4096
  ds_read_b64_tr_b16 v[98:99], v108 offset:4608
  v_mfma_f32_16x16x32_bf16 v[32:35], v[56:59], v[56:59], v[32:35]
  ds_read_b64_tr_b16 v[100:101], v109 offset:4096
  ds_read_b64_tr_b16 v[102:103], v109 offset:4608
  v_mfma_f32_16x16x32_bf16 v[132:135], v[40:43], v[56:59], v[132:135]
  s_waitcnt lgkmcnt(10)
  v_mfma_f32_16x16x32_bf16 v[16:19], v[56:59], v[80:83], v[16:19]
  v_mfma_f32_16x16x32_bf16 v[20:23], v[60:63], v[80:83], v[20:23]
  s_add_u32 m0, s30, 18432
  s_nop 0
  buffer_load_dwordx4 v111, s[60:63], s32 offen lds
  v_mfma_f32_16x16x32_bf16 v[24:27], v[56:59], v[84:87], v[24:27]
  v_mfma_f32_16x16x32_bf16 v[28:31], v[60:63], v[84:87], v[28:31]
  s_add_u32 m0, s31, 73600
  s_nop 0
  buffer_load_dwordx4 v112, s[68:71], s35 offen offset:128 lds
  s_cmp_eq_u32 s28, 2
  s_cbranch_scc0 sequential_preLN__mha_block__moe_arch_mod__prompt_kernel_cs46
  v_mfma_f32_16x16x32_bf16 v[36:39], v[40:43], v[72:75], v[36:39]
  v_mfma_f32_16x16x32_bf16 v[36:39], v[44:47], v[76:79], v[36:39]
  v_mfma_f32_16x16x32_bf16 v[36:39], v[48:51], v[80:83], v[36:39]
  v_mfma_f32_16x16x32_bf16 v[36:39], v[52:55], v[84:87], v[36:39]
sequential_preLN__mha_block__moe_arch_mod__prompt_kernel_cs46:
  s_waitcnt vmcnt(12) lgkmcnt(0)
  s_barrier
  s_cmp_eq_u32 s26, 0
  s_cbranch_scc0 sequential_preLN__mha_block__moe_arch_mod__prompt_kernel_fr47
  s_mov_b32 s3, 0x80808080
  s_waitcnt vmcnt(14)
sequential_preLN__mha_block__moe_arch_mod__prompt_kernel_dchk48:
  v_and_b32 v164, s3, v161
  v_cmp_ne_u32 vcc, s3, v164
  s_nop 4
  s_cbranch_vccz sequential_preLN__mha_block__moe_arch_mod__prompt_kernel_dok49
  s_sub_u32 s75, s75, 1
  s_cbranch_scc1 sequential_preLN__mha_block__moe_arch_mod__prompt_kernel_end1
  buffer_load_dword v161, v162, s[56:59], 0 offen sc1
  s_waitcnt vmcnt(0)
  s_branch sequential_preLN__mha_block__moe_arch_mod__prompt_kernel_dchk48
sequential_preLN__mha_block__moe_arch_mod__prompt_kernel_dok49:
sequential_preLN__mha_block__moe_arch_mod__prompt_kernel_fr47:
  v_mfma_f32_16x16x32_bf16 v[0:3], v[64:67], v[88:91], v[0:3]
  ds_read_b128 v[56:59], v104 offset:4096
  ds_read_b64_tr_b16 v[72:73], v106 offset:8192
  v_mfma_f32_16x16x32_bf16 v[4:7], v[68:71], v[88:91], v[4:7]
  ds_read_b64_tr_b16 v[74:75], v106 offset:8704
  ds_read_b128 v[60:63], v105 offset:4096
  v_mfma_f32_16x16x32_bf16 v[8:11], v[64:67], v[92:95], v[8:11]
  ds_read_b64_tr_b16 v[76:77], v107 offset:8192
  ds_read_b64_tr_b16 v[78:79], v107 offset:8704
  v_mfma_f32_16x16x32_bf16 v[12:15], v[68:71], v[92:95], v[12:15]
  ds_read_b64_tr_b16 v[80:81], v108 offset:8192
  ds_read_b64_tr_b16 v[82:83], v108 offset:8704
  v_mfma_f32_16x16x32_bf16 v[32:35], v[64:67], v[64:67], v[32:35]
  ds_read_b64_tr_b16 v[84:85], v109 offset:8192
  ds_read_b64_tr_b16 v[86:87], v109 offset:8704
  v_mfma_f32_16x16x32_bf16 v[132:135], v[40:43], v[64:67], v[132:135]
  v_mfma_f32_16x16x32_bf16 v[16:19], v[64:67], v[96:99], v[16:19]
  v_mfma_f32_16x16x32_bf16 v[20:23], v[68:71], v[96:99], v[20:23]
  buffer_load_dwordx4 v[178:181], v228, s[60:63], s43 offen
  v_mfma_f32_16x16x32_bf16 v[24:27], v[64:67], v[100:103], v[24:27]
  v_mfma_f32_16x16x32_bf16 v[28:31], v[68:71], v[100:103], v[28:31]
  buffer_load_dword v182, v228, s[60:63], s43 offen offset:16
  s_cmp_eq_u32 s28, 3
  s_cbranch_scc0 sequential_preLN__mha_block__moe_arch_mod__prompt_kernel_cs50
  v_mfma_f32_16x16x32_bf16 v[36:39], v[40:43], v[88:91], v[36:39]
  v_mfma_f32_16x16x32_bf16 v[36:39], v[44:47], v[92:95], v[36:39]
  v_mfma_f32_16x16x32_bf16 v[36:39], v[48:51], v[96:99], v[36:39]
  v_mfma_f32_16x16x32_bf16 v[36:39], v[52:55], v[100:103], v[36:39]
sequential_preLN__mha_block__moe_arch_mod__prompt_kernel_cs50:
  s_waitcnt lgkmcnt(4)
  v_mfma_f32_16x16x32_bf16 v[0:3], v[56:59], v[72:75], v[0:3]
  ds_read_b128 v[64:67], v136 offset:4096
  ds_read_b64_tr_b16 v[88:89], v106 offset:12288
  v_mfma_f32_16x16x32_bf16 v[4:7], v[60:63], v[72:75], v[4:7]
  ds_read_b64_tr_b16 v[90:91], v106 offset:12800
  ds_read_b128 v[68:71], v137 offset:4096
  v_mfma_f32_16x16x32_bf16 v[8:11], v[56:59], v[76:79], v[8:11]
  ds_read_b64_tr_b16 v[92:93], v107 offset:12288
  ds_read_b64_tr_b16 v[94:95], v107 offset:12800
  v_mfma_f32_16x16x32_bf16 v[12:15], v[60:63], v[76:79], v[12:15]
  ds_read_b64_tr_b16 v[96:97], v108 offset:12288
  ds_read_b64_tr_b16 v[98:99], v108 offset:12800
  v_mfma_f32_16x16x32_bf16 v[32:35], v[56:59], v[56:59], v[32:35]
  ds_read_b64_tr_b16 v[100:101], v109 offset:12288
  ds_read_b64_tr_b16 v[102:103], v109 offset:12800
  v_mfma_f32_16x16x32_bf16 v[132:135], v[40:43], v[56:59], v[132:135]
  s_waitcnt lgkmcnt(10)
  v_mfma_f32_16x16x32_bf16 v[16:19], v[56:59], v[80:83], v[16:19]
  v_mfma_f32_16x16x32_bf16 v[20:23], v[60:63], v[80:83], v[20:23]
  buffer_load_dwordx4 v[184:187], v229, s[64:67], s42 offen
  v_mfma_f32_16x16x32_bf16 v[24:27], v[56:59], v[84:87], v[24:27]
  v_mfma_f32_16x16x32_bf16 v[28:31], v[60:63], v[84:87], v[28:31]
  buffer_load_dword v188, v229, s[64:67], s42 offen offset:16
  s_cmp_eq_u32 s28, 0
  s_cbranch_scc0 sequential_preLN__mha_block__moe_arch_mod__prompt_kernel_cs51
  v_mfma_f32_16x16x32_bf16 v[36:39], v[40:43], v[72:75], v[36:39]
  v_mfma_f32_16x16x32_bf16 v[36:39], v[44:47], v[76:79], v[36:39]
  v_mfma_f32_16x16x32_bf16 v[36:39], v[48:51], v[80:83], v[36:39]
  v_mfma_f32_16x16x32_bf16 v[36:39], v[52:55], v[84:87], v[36:39]
sequential_preLN__mha_block__moe_arch_mod__prompt_kernel_cs51:
  s_waitcnt vmcnt(12) lgkmcnt(0)
  s_barrier
  v_mfma_f32_16x16x32_bf16 v[0:3], v[64:67], v[88:91], v[0:3]
  ds_read_b128 v[56:59], v104 offset:8192
  ds_read_b64_tr_b16 v[72:73], v106 offset:16384
  v_mfma_f32_16x16x32_bf16 v[4:7], v[68:71], v[88:91], v[4:7]
  ds_read_b64_tr_b16 v[74:75], v106 offset:16896
  ds_read_b128 v[60:63], v105 offset:8192
  v_mfma_f32_16x16x32_bf16 v[8:11], v[64:67], v[92:95], v[8:11]
  ds_read_b64_tr_b16 v[76:77], v107 offset:16384
  ds_read_b64_tr_b16 v[78:79], v107 offset:16896
  v_mfma_f32_16x16x32_bf16 v[12:15], v[68:71], v[92:95], v[12:15]
  ds_read_b64_tr_b16 v[80:81], v108 offset:16384
  ds_read_b64_tr_b16 v[82:83], v108 offset:16896
  v_mfma_f32_16x16x32_bf16 v[32:35], v[64:67], v[64:67], v[32:35]
  ds_read_b64_tr_b16 v[84:85], v109 offset:16384
  ds_read_b64_tr_b16 v[86:87], v109 offset:16896
  v_mfma_f32_16x16x32_bf16 v[132:135], v[40:43], v[64:67], v[132:135]
  v_mfma_f32_16x16x32_bf16 v[16:19], v[64:67], v[96:99], v[16:19]
  v_mfma_f32_16x16x32_bf16 v[20:23], v[68:71], v[96:99], v[20:23]
  buffer_load_dwordx4 v[222:225], v227, s[64:67], 0 offen
  v_mfma_f32_16x16x32_bf16 v[24:27], v[64:67], v[100:103], v[24:27]
  v_mfma_f32_16x16x32_bf16 v[28:31], v[68:71], v[100:103], v[28:31]
  buffer_load_dword v226, v227, s[64:67], 0 offen offset:16
  s_cmp_eq_u32 s28, 1
  s_cbranch_scc0 sequential_preLN__mha_block__moe_arch_mod__prompt_kernel_cs52
  v_mfma_f32_16x16x32_bf16 v[36:39], v[40:43], v[88:91], v[36:39]
  v_mfma_f32_16x16x32_bf16 v[36:39], v[44:47], v[92:95], v[36:39]
  v_mfma_f32_16x16x32_bf16 v[36:39], v[48:51], v[96:99], v[36:39]
  v_mfma_f32_16x16x32_bf16 v[36:39], v[52:55], v[100:103], v[36:39]
sequential_preLN__mha_block__moe_arch_mod__prompt_kernel_cs52:
  s_waitcnt lgkmcnt(4)
  v_mfma_f32_16x16x32_bf16 v[0:3], v[56:59], v[72:75], v[0:3]
  ds_read_b128 v[64:67], v136 offset:8192
  ds_read_b64_tr_b16 v[88:89], v106 offset:20480
  v_mfma_f32_16x16x32_bf16 v[4:7], v[60:63], v[72:75], v[4:7]
  ds_read_b64_tr_b16 v[90:91], v106 offset:20992
  ds_read_b128 v[68:71], v137 offset:8192
  v_mfma_f32_16x16x32_bf16 v[8:11], v[56:59], v[76:79], v[8:11]
  ds_read_b64_tr_b16 v[92:93], v107 offset:20480
  ds_read_b64_tr_b16 v[94:95], v107 offset:20992
  v_mfma_f32_16x16x32_bf16 v[12:15], v[60:63], v[76:79], v[12:15]
  ds_read_b64_tr_b16 v[96:97], v108 offset:20480
  ds_read_b64_tr_b16 v[98:99], v108 offset:20992
  v_mfma_f32_16x16x32_bf16 v[32:35], v[56:59], v[56:59], v[32:35]
  ds_read_b64_tr_b16 v[100:101], v109 offset:20480
  ds_read_b64_tr_b16 v[102:103], v109 offset:20992
  v_mfma_f32_16x16x32_bf16 v[132:135], v[40:43], v[56:59], v[132:135]
  s_waitcnt lgkmcnt(10)
  v_mfma_f32_16x16x32_bf16 v[16:19], v[56:59], v[80:83], v[16:19]
  v_mfma_f32_16x16x32_bf16 v[20:23], v[60:63], v[80:83], v[20:23]
  v_mfma_f32_16x16x32_bf16 v[24:27], v[56:59], v[84:87], v[24:27]
  v_mfma_f32_16x16x32_bf16 v[28:31], v[60:63], v[84:87], v[28:31]
  s_cmp_eq_u32 s28, 2
  s_cbranch_scc0 sequential_preLN__mha_block__moe_arch_mod__prompt_kernel_cs53
  v_mfma_f32_16x16x32_bf16 v[36:39], v[40:43], v[72:75], v[36:39]
  v_mfma_f32_16x16x32_bf16 v[36:39], v[44:47], v[76:79], v[36:39]
  v_mfma_f32_16x16x32_bf16 v[36:39], v[48:51], v[80:83], v[36:39]
  v_mfma_f32_16x16x32_bf16 v[36:39], v[52:55], v[84:87], v[36:39]
sequential_preLN__mha_block__moe_arch_mod__prompt_kernel_cs53:
  s_waitcnt vmcnt(10) lgkmcnt(0)
  s_barrier
  v_mfma_f32_16x16x32_bf16 v[0:3], v[64:67], v[88:91], v[0:3]
  ds_read_b128 v[56:59], v104 offset:12288
  ds_read_b64_tr_b16 v[72:73], v106 offset:24576
  v_mfma_f32_16x16x32_bf16 v[4:7], v[68:71], v[88:91], v[4:7]
  ds_read_b64_tr_b16 v[74:75], v106 offset:25088
  ds_read_b128 v[60:63], v105 offset:12288
  v_mfma_f32_16x16x32_bf16 v[8:11], v[64:67], v[92:95], v[8:11]
  ds_read_b64_tr_b16 v[76:77], v107 offset:24576
  ds_read_b64_tr_b16 v[78:79], v107 offset:25088
  v_mfma_f32_16x16x32_bf16 v[12:15], v[68:71], v[92:95], v[12:15]
  ds_read_b64_tr_b16 v[80:81], v108 offset:24576
  ds_read_b64_tr_b16 v[82:83], v108 offset:25088
  v_mfma_f32_16x16x32_bf16 v[32:35], v[64:67], v[64:67], v[32:35]
  ds_read_b64_tr_b16 v[84:85], v109 offset:24576
  ds_read_b64_tr_b16 v[86:87], v109 offset:25088
  v_mfma_f32_16x16x32_bf16 v[132:135], v[40:43], v[64:67], v[132:135]
  v_mfma_f32_16x16x32_bf16 v[16:19], v[64:67], v[96:99], v[16:19]
  v_mfma_f32_16x16x32_bf16 v[20:23], v[68:71], v[96:99], v[20:23]
  v_mfma_f32_16x16x32_bf16 v[24:27], v[64:67], v[100:103], v[24:27]
  v_mfma_f32_16x16x32_bf16 v[28:31], v[68:71], v[100:103], v[28:31]
  s_cmp_eq_u32 s28, 3
  s_cbranch_scc0 sequential_preLN__mha_block__moe_arch_mod__prompt_kernel_cs54
  v_mfma_f32_16x16x32_bf16 v[36:39], v[40:43], v[88:91], v[36:39]
  v_mfma_f32_16x16x32_bf16 v[36:39], v[44:47], v[92:95], v[36:39]
  v_mfma_f32_16x16x32_bf16 v[36:39], v[48:51], v[96:99], v[36:39]
  v_mfma_f32_16x16x32_bf16 v[36:39], v[52:55], v[100:103], v[36:39]
sequential_preLN__mha_block__moe_arch_mod__prompt_kernel_cs54:
  s_waitcnt lgkmcnt(4)
  v_mfma_f32_16x16x32_bf16 v[0:3], v[56:59], v[72:75], v[0:3]
  ds_read_b128 v[64:67], v136 offset:12288
  ds_read_b64_tr_b16 v[88:89], v106 offset:28672
  v_mfma_f32_16x16x32_bf16 v[4:7], v[60:63], v[72:75], v[4:7]
  ds_read_b64_tr_b16 v[90:91], v106 offset:29184
  ds_read_b128 v[68:71], v137 offset:12288
  v_mfma_f32_16x16x32_bf16 v[8:11], v[56:59], v[76:79], v[8:11]
  ds_read_b64_tr_b16 v[92:93], v107 offset:28672
  ds_read_b64_tr_b16 v[94:95], v107 offset:29184
  v_mfma_f32_16x16x32_bf16 v[12:15], v[60:63], v[76:79], v[12:15]
  ds_read_b64_tr_b16 v[96:97], v108 offset:28672
  ds_read_b64_tr_b16 v[98:99], v108 offset:29184
  v_mfma_f32_16x16x32_bf16 v[32:35], v[56:59], v[56:59], v[32:35]
  ds_read_b64_tr_b16 v[100:101], v109 offset:28672
  ds_read_b64_tr_b16 v[102:103], v109 offset:29184
  v_mfma_f32_16x16x32_bf16 v[132:135], v[40:43], v[56:59], v[132:135]
  s_waitcnt lgkmcnt(10)
  v_mfma_f32_16x16x32_bf16 v[16:19], v[56:59], v[80:83], v[16:19]
  v_mfma_f32_16x16x32_bf16 v[20:23], v[60:63], v[80:83], v[20:23]
  v_mfma_f32_16x16x32_bf16 v[24:27], v[56:59], v[84:87], v[24:27]
  v_mfma_f32_16x16x32_bf16 v[28:31], v[60:63], v[84:87], v[28:31]
  s_cmp_eq_u32 s28, 0
  s_cbranch_scc0 sequential_preLN__mha_block__moe_arch_mod__prompt_kernel_cs55
  v_mfma_f32_16x16x32_bf16 v[36:39], v[40:43], v[72:75], v[36:39]
  v_mfma_f32_16x16x32_bf16 v[36:39], v[44:47], v[76:79], v[36:39]
  v_mfma_f32_16x16x32_bf16 v[36:39], v[48:51], v[80:83], v[36:39]
  v_mfma_f32_16x16x32_bf16 v[36:39], v[52:55], v[84:87], v[36:39]
sequential_preLN__mha_block__moe_arch_mod__prompt_kernel_cs55:
  s_waitcnt vmcnt(6) lgkmcnt(0)
  s_barrier
  v_mfma_f32_16x16x32_bf16 v[0:3], v[64:67], v[88:91], v[0:3]
  ds_read_b128 v[56:59], v104 offset:16384
  ds_read_b64_tr_b16 v[72:73], v106 offset:32768
  v_mfma_f32_16x16x32_bf16 v[4:7], v[68:71], v[88:91], v[4:7]
  ds_read_b64_tr_b16 v[74:75], v106 offset:33280
  ds_read_b128 v[60:63], v105 offset:16384
  v_mfma_f32_16x16x32_bf16 v[8:11], v[64:67], v[92:95], v[8:11]
  ds_read_b64_tr_b16 v[76:77], v107 offset:32768
  ds_read_b64_tr_b16 v[78:79], v107 offset:33280
  v_mfma_f32_16x16x32_bf16 v[12:15], v[68:71], v[92:95], v[12:15]
  ds_read_b64_tr_b16 v[80:81], v108 offset:32768
  ds_read_b64_tr_b16 v[82:83], v108 offset:33280
  v_mfma_f32_16x16x32_bf16 v[32:35], v[64:67], v[64:67], v[32:35]
  ds_read_b64_tr_b16 v[84:85], v109 offset:32768
  ds_read_b64_tr_b16 v[86:87], v109 offset:33280
  v_mfma_f32_16x16x32_bf16 v[132:135], v[40:43], v[64:67], v[132:135]
  v_mfma_f32_16x16x32_bf16 v[16:19], v[64:67], v[96:99], v[16:19]
  v_mfma_f32_16x16x32_bf16 v[20:23], v[68:71], v[96:99], v[20:23]
  v_mfma_f32_16x16x32_bf16 v[24:27], v[64:67], v[100:103], v[24:27]
  v_mfma_f32_16x16x32_bf16 v[28:31], v[68:71], v[100:103], v[28:31]
  s_cmp_eq_u32 s28, 1
  s_cbranch_scc0 sequential_preLN__mha_block__moe_arch_mod__prompt_kernel_cs56
  v_mfma_f32_16x16x32_bf16 v[36:39], v[40:43], v[88:91], v[36:39]
  v_mfma_f32_16x16x32_bf16 v[36:39], v[44:47], v[92:95], v[36:39]
  v_mfma_f32_16x16x32_bf16 v[36:39], v[48:51], v[96:99], v[36:39]
  v_mfma_f32_16x16x32_bf16 v[36:39], v[52:55], v[100:103], v[36:39]
sequential_preLN__mha_block__moe_arch_mod__prompt_kernel_cs56:
  s_waitcnt lgkmcnt(4)
  v_mfma_f32_16x16x32_bf16 v[0:3], v[56:59], v[72:75], v[0:3]
  ds_read_b128 v[64:67], v136 offset:16384
  ds_read_b64_tr_b16 v[88:89], v106 offset:36864
  v_mfma_f32_16x16x32_bf16 v[4:7], v[60:63], v[72:75], v[4:7]
  ds_read_b64_tr_b16 v[90:91], v106 offset:37376
  ds_read_b128 v[68:71], v137 offset:16384
  v_mfma_f32_16x16x32_bf16 v[8:11], v[56:59], v[76:79], v[8:11]
  ds_read_b64_tr_b16 v[92:93], v107 offset:36864
  ds_read_b64_tr_b16 v[94:95], v107 offset:37376
  v_mfma_f32_16x16x32_bf16 v[12:15], v[60:63], v[76:79], v[12:15]
  ds_read_b64_tr_b16 v[96:97], v108 offset:36864
  ds_read_b64_tr_b16 v[98:99], v108 offset:37376
  v_mfma_f32_16x16x32_bf16 v[32:35], v[56:59], v[56:59], v[32:35]
  ds_read_b64_tr_b16 v[100:101], v109 offset:36864
  ds_read_b64_tr_b16 v[102:103], v109 offset:37376
  v_mfma_f32_16x16x32_bf16 v[132:135], v[40:43], v[56:59], v[132:135]
  s_waitcnt lgkmcnt(10)
  v_mfma_f32_16x16x32_bf16 v[16:19], v[56:59], v[80:83], v[16:19]
  v_mfma_f32_16x16x32_bf16 v[20:23], v[60:63], v[80:83], v[20:23]
  v_mfma_f32_16x16x32_bf16 v[24:27], v[56:59], v[84:87], v[24:27]
  v_mfma_f32_16x16x32_bf16 v[28:31], v[60:63], v[84:87], v[28:31]
  s_cmp_eq_u32 s28, 2
  s_cbranch_scc0 sequential_preLN__mha_block__moe_arch_mod__prompt_kernel_cs57
  v_mfma_f32_16x16x32_bf16 v[36:39], v[40:43], v[72:75], v[36:39]
  v_mfma_f32_16x16x32_bf16 v[36:39], v[44:47], v[76:79], v[36:39]
  v_mfma_f32_16x16x32_bf16 v[36:39], v[48:51], v[80:83], v[36:39]
  v_mfma_f32_16x16x32_bf16 v[36:39], v[52:55], v[84:87], v[36:39]
sequential_preLN__mha_block__moe_arch_mod__prompt_kernel_cs57:
  s_waitcnt lgkmcnt(0)
  v_mfma_f32_16x16x32_bf16 v[32:35], v[64:67], v[64:67], v[32:35]
  v_mfma_f32_16x16x32_bf16 v[132:135], v[40:43], v[64:67], v[132:135]
  s_cmp_eq_u32 s28, 3
  s_cbranch_scc0 sequential_preLN__mha_block__moe_arch_mod__prompt_kernel_cs58
  v_mfma_f32_16x16x32_bf16 v[36:39], v[40:43], v[88:91], v[36:39]
  v_mfma_f32_16x16x32_bf16 v[36:39], v[44:47], v[92:95], v[36:39]
  v_mfma_f32_16x16x32_bf16 v[36:39], v[48:51], v[96:99], v[36:39]
  v_mfma_f32_16x16x32_bf16 v[36:39], v[52:55], v[100:103], v[36:39]
sequential_preLN__mha_block__moe_arch_mod__prompt_kernel_cs58:
  v_mfma_f32_16x16x32_bf16 v[0:3], v[64:67], v[88:91], v[0:3]
  v_mfma_f32_16x16x32_bf16 v[4:7], v[68:71], v[88:91], v[4:7]
  v_mfma_f32_16x16x32_bf16 v[8:11], v[64:67], v[92:95], v[8:11]
  v_mfma_f32_16x16x32_bf16 v[12:15], v[68:71], v[92:95], v[12:15]
  v_mfma_f32_16x16x32_bf16 v[16:19], v[64:67], v[96:99], v[16:19]
  v_mfma_f32_16x16x32_bf16 v[20:23], v[68:71], v[96:99], v[20:23]
  v_mfma_f32_16x16x32_bf16 v[24:27], v[64:67], v[100:103], v[24:27]
  v_mfma_f32_16x16x32_bf16 v[28:31], v[68:71], v[100:103], v[28:31]
  v_cndmask_b32 v56, v32, v33, s[50:51]
  v_cndmask_b32 v56, v56, v34, s[52:53]
  v_cndmask_b32 v56, v56, v35, s[54:55]
  s_mov_b64 exec, 0xffff
  ds_write_b32 v118, v132
  ds_write_b32 v120, v36 offset:1024
  ds_write_b32 v120, v37 offset:1280
  ds_write_b32 v120, v38 offset:1536
  ds_write_b32 v120, v39 offset:1792
  s_mov_b32 exec_lo, 0x00f0000f
  s_mov_b32 exec_hi, 0xf0000f00
  ds_write_b32 v118, v56 offset:512
  s_mov_b64 exec, -1
  s_waitcnt lgkmcnt(0)
  s_barrier
  ds_read_b128 v[72:75], v121 offset:1024
  ds_read2_b32 v[60:61], v118 offset0:0 offset1:128
  ds_read2_b32 v[64:65], v122 offset0:0 offset1:128
  ds_read2_b32 v[68:69], v119 offset0:0 offset1:128
  s_mov_b32 s3, 0x3acccccd
  s_mov_b32 s11, 0x07060302
  s_waitcnt lgkmcnt(3)
  v_add_f32 v72, v72, v73
  v_add_f32 v74, v74, v75
  v_add_f32 v72, v72, v74
  v_and_b32 v73, 0xffff0000, v72
  v_sub_f32 v73, v72, v73
  v_and_b32 v74, 0xffff0000, v73
  v_sub_f32 v74, v73, v74
  v_perm_b32 v76, v73, v72, s11
  v_cvt_pk_bf16_f32 v77, v74, 0
  s_waitcnt lgkmcnt(0)
  v_mul_f32 v60, s3, v60
  v_mul_f32 v64, s3, v64
  v_mul_f32 v68, s3, v68
  v_mul_f32 v61, s3, v61
  v_mul_f32 v65, s3, v65
  v_mul_f32 v69, s3, v69
  v_mov_b32_dpp v124, v76 quad_perm:[0,1,2,3] row_mask:0x1 bank_mask:0xf
  v_mov_b32_dpp v125, v77 quad_perm:[0,1,2,3] row_mask:0x1 bank_mask:0xf
  v_mov_b32_dpp v126, v76 quad_perm:[0,1,2,3] row_mask:0x2 bank_mask:0xf
  v_mov_b32_dpp v127, v77 quad_perm:[0,1,2,3] row_mask:0x2 bank_mask:0xf
  v_mov_b32_dpp v128, v76 quad_perm:[0,1,2,3] row_mask:0x4 bank_mask:0xf
  v_mov_b32_dpp v129, v77 quad_perm:[0,1,2,3] row_mask:0x4 bank_mask:0xf
  v_mov_b32_dpp v130, v76 quad_perm:[0,1,2,3] row_mask:0x8 bank_mask:0xf
  v_mov_b32_dpp v131, v77 quad_perm:[0,1,2,3] row_mask:0x8 bank_mask:0xf
  v_cvt_pk_bf16_f32 v62, -v60, -v60
  v_cvt_pk_bf16_f32 v66, -v64, -v64
  v_fma_f32 v61, -v60, v60, v61
  v_fma_f32 v65, -v64, v64, v65
  v_fma_f32 v69, -v68, v68, v69
  v_and_b32 v63, 0xffff, v62
  v_and_b32 v67, 0xffff, v66
  v_max_f32 v61, 0, v61
  v_max_f32 v65, 0, v65
  v_max_f32 v69, 0, v69
  v_mfma_f32_16x16x16_bf16 v[0:3], v[62:63], v[124:125], v[0:3]
  v_cvt_pk_bf16_f32 v69, v69, v69
  v_mfma_f32_16x16x16_bf16 v[4:7], v[66:67], v[124:125], v[4:7]
  v_and_b32 v69, 0xffff0000, v69
  v_mfma_f32_16x16x16_bf16 v[8:11], v[62:63], v[126:127], v[8:11]
  v_add_f32 v69, 0x3727c5ac, v69
  v_mfma_f32_16x16x16_bf16 v[12:15], v[66:67], v[126:127], v[12:15]
  v_cvt_pk_bf16_f32 v69, v69, v69
  v_mfma_f32_16x16x16_bf16 v[16:19], v[62:63], v[128:129], v[16:19]
  v_and_b32 v69, 0xffff0000, v69
  v_mfma_f32_16x16x16_bf16 v[20:23], v[66:67], v[128:129], v[20:23]
  v_sqrt_f32 v69, v69
  v_mfma_f32_16x16x16_bf16 v[24:27], v[62:63], v[130:131], v[24:27]
  v_cvt_pk_bf16_f32 v69, v69, v69
  v_mfma_f32_16x16x16_bf16 v[28:31], v[66:67], v[130:131], v[28:31]
  v_and_b32 v69, 0xffff0000, v69
  v_rcp_f32 v69, v69
  s_cmp_eq_u32 s101, 0
  s_cselect_b32 s22, s22, 0
  v_mul_f32_dpp v0, v69, v0 row_newbcast:0 row_mask:0xf bank_mask:0xf
  v_mul_f32_dpp v1, v69, v1 row_newbcast:1 row_mask:0xf bank_mask:0xf
  v_mul_f32_dpp v2, v69, v2 row_newbcast:2 row_mask:0xf bank_mask:0xf
  v_mul_f32_dpp v3, v69, v3 row_newbcast:3 row_mask:0xf bank_mask:0xf
  v_mul_f32_dpp v4, v69, v4 row_newbcast:4 row_mask:0xf bank_mask:0xf
  v_mul_f32_dpp v5, v69, v5 row_newbcast:5 row_mask:0xf bank_mask:0xf
  v_mul_f32_dpp v6, v69, v6 row_newbcast:6 row_mask:0xf bank_mask:0xf
  v_mul_f32_dpp v7, v69, v7 row_newbcast:7 row_mask:0xf bank_mask:0xf
  v_cvt_pk_bf16_f32 v190, v0, v1
  v_cvt_pk_bf16_f32 v191, v2, v3
  v_cvt_pk_bf16_f32 v192, v4, v5
  v_cvt_pk_bf16_f32 v193, v6, v7
  v_mul_f32_dpp v8, v69, v8 row_newbcast:0 row_mask:0xf bank_mask:0xf
  v_mul_f32_dpp v9, v69, v9 row_newbcast:1 row_mask:0xf bank_mask:0xf
  v_mul_f32_dpp v10, v69, v10 row_newbcast:2 row_mask:0xf bank_mask:0xf
  v_mul_f32_dpp v11, v69, v11 row_newbcast:3 row_mask:0xf bank_mask:0xf
  v_mul_f32_dpp v12, v69, v12 row_newbcast:4 row_mask:0xf bank_mask:0xf
  v_mul_f32_dpp v13, v69, v13 row_newbcast:5 row_mask:0xf bank_mask:0xf
  v_mul_f32_dpp v14, v69, v14 row_newbcast:6 row_mask:0xf bank_mask:0xf
  v_mul_f32_dpp v15, v69, v15 row_newbcast:7 row_mask:0xf bank_mask:0xf
  v_cvt_pk_bf16_f32 v194, v8, v9
  v_cvt_pk_bf16_f32 v195, v10, v11
  v_cvt_pk_bf16_f32 v196, v12, v13
  v_cvt_pk_bf16_f32 v197, v14, v15
  v_permlane32_swap_b32 v190, v192
  v_permlane32_swap_b32 v191, v193
  buffer_store_dwordx4 v[190:193], v208, s[20:23], 0 offen sc1
  v_mul_f32_dpp v16, v69, v16 row_newbcast:0 row_mask:0xf bank_mask:0xf
  v_mul_f32_dpp v17, v69, v17 row_newbcast:1 row_mask:0xf bank_mask:0xf
  v_mul_f32_dpp v18, v69, v18 row_newbcast:2 row_mask:0xf bank_mask:0xf
  v_mul_f32_dpp v19, v69, v19 row_newbcast:3 row_mask:0xf bank_mask:0xf
  v_mul_f32_dpp v20, v69, v20 row_newbcast:4 row_mask:0xf bank_mask:0xf
  v_mul_f32_dpp v21, v69, v21 row_newbcast:5 row_mask:0xf bank_mask:0xf
  v_mul_f32_dpp v22, v69, v22 row_newbcast:6 row_mask:0xf bank_mask:0xf
  v_mul_f32_dpp v23, v69, v23 row_newbcast:7 row_mask:0xf bank_mask:0xf
  v_cvt_pk_bf16_f32 v198, v16, v17
  v_cvt_pk_bf16_f32 v199, v18, v19
  v_cvt_pk_bf16_f32 v200, v20, v21
  v_cvt_pk_bf16_f32 v201, v22, v23
  v_permlane32_swap_b32 v194, v196
  v_permlane32_swap_b32 v195, v197
  buffer_store_dwordx4 v[194:197], v209, s[20:23], 0 offen sc1
  v_mul_f32_dpp v24, v69, v24 row_newbcast:0 row_mask:0xf bank_mask:0xf
  v_mul_f32_dpp v25, v69, v25 row_newbcast:1 row_mask:0xf bank_mask:0xf
  v_mul_f32_dpp v26, v69, v26 row_newbcast:2 row_mask:0xf bank_mask:0xf
  v_mul_f32_dpp v27, v69, v27 row_newbcast:3 row_mask:0xf bank_mask:0xf
  v_mul_f32_dpp v28, v69, v28 row_newbcast:4 row_mask:0xf bank_mask:0xf
  v_mul_f32_dpp v29, v69, v29 row_newbcast:5 row_mask:0xf bank_mask:0xf
  v_mul_f32_dpp v30, v69, v30 row_newbcast:6 row_mask:0xf bank_mask:0xf
  v_mul_f32_dpp v31, v69, v31 row_newbcast:7 row_mask:0xf bank_mask:0xf
  v_cvt_pk_bf16_f32 v202, v24, v25
  v_cvt_pk_bf16_f32 v203, v26, v27
  v_cvt_pk_bf16_f32 v204, v28, v29
  v_cvt_pk_bf16_f32 v205, v30, v31
  v_permlane32_swap_b32 v198, v200
  v_permlane32_swap_b32 v199, v201
  buffer_store_dwordx4 v[198:201], v210, s[20:23], 0 offen sc1
  v_permlane32_swap_b32 v202, v204
  v_permlane32_swap_b32 v203, v205
  buffer_store_dwordx4 v[202:205], v211, s[20:23], 0 offen sc1
  s_mov_b32 s22, 268435456
  s_branch sequential_preLN__mha_block__moe_arch_mod__prompt_kernel_join6
sequential_preLN__mha_block__moe_arch_mod__prompt_kernel_spare2:
  s_sub_u32 s73, s2, 240
  s_mul_i32 s73, s73, 0
  s_waitcnt vmcnt(0) lgkmcnt(0)
  s_barrier
  s_mov_b32 s72, 0x80
  s_cmp_eq_u32 s26, 0
  s_cbranch_scc0 sequential_preLN__mha_block__moe_arch_mod__prompt_kernel_fl59
  v_mov_b32 v164, s72
  s_mov_b64 exec, 1
  buffer_store_byte v164, off, s[56:59], s2 sc1
  s_mov_b64 exec, -1
sequential_preLN__mha_block__moe_arch_mod__prompt_kernel_fl59:
  buffer_load_dwordx4 v[178:181], v228, s[60:63], s43 offen
  buffer_load_dword v182, v228, s[60:63], s43 offen offset:16
  buffer_load_dwordx4 v[184:187], v229, s[64:67], s42 offen
  buffer_load_dword v188, v229, s[64:67], s42 offen offset:16
  buffer_load_dwordx4 v[222:225], v227, s[64:67], 0 offen
  buffer_load_dword v226, v227, s[64:67], 0 offen offset:16
  v_mov_b32 v161, 0
  s_mov_b32 s101, 0
  s_mov_b32 s3, 0x80808080
  v_mov_b32 v208, 0x40000000
  v_mov_b32 v209, 0x40000000
  v_mov_b32 v210, 0x40000000
  v_mov_b32 v211, 0x40000000
  v_mov_b32 v212, 0x40000000
  v_mov_b32 v213, 0x40000000
  v_mov_b32 v214, 0x40000000
  v_mov_b32 v215, 0x40000000
  v_mov_b32 v216, 0x40000000
  v_mov_b32 v217, 0x40000000
  v_mov_b32 v218, 0x40000000
  v_mov_b32 v219, 0x40000000
  s_cmp_lg_u32 s26, 0
  s_cbranch_scc1 sequential_preLN__mha_block__moe_arch_mod__prompt_kernel_sw60
sequential_preLN__mha_block__moe_arch_mod__prompt_kernel_dchk61:
  v_and_b32 v164, s3, v161
  v_cmp_ne_u32 vcc, s3, v164
  s_nop 4
  s_cbranch_vccz sequential_preLN__mha_block__moe_arch_mod__prompt_kernel_dok62
  s_sub_u32 s75, s75, 1
  s_cbranch_scc1 sequential_preLN__mha_block__moe_arch_mod__prompt_kernel_end1
  s_sleep 8
  buffer_load_dword v161, v162, s[56:59], 0 offen sc1
  s_waitcnt vmcnt(0)
  s_branch sequential_preLN__mha_block__moe_arch_mod__prompt_kernel_dchk61
sequential_preLN__mha_block__moe_arch_mod__prompt_kernel_dok62:
sequential_preLN__mha_block__moe_arch_mod__prompt_kernel_sw60:
sequential_preLN__mha_block__moe_arch_mod__prompt_kernel_join6:
  s_mul_i32 s30, s24, 163840
  s_add_u32 s30, s30, 2621440
  s_lshl_b32 s31, s26, 10
  s_lshl_b32 s27, s25, 3
  s_add_u32 s27, s27, s26
  s_mul_i32 s39, s24, 81920
  s_mul_i32 s3, s27, 1280
  s_add_u32 s39, s39, s3
  v_lshlrev_b32 v1, 3, v156
  s_add_u32 s32, s30, s31
  s_waitcnt vmcnt(0)
  s_barrier
  s_cmp_ge_u32 s2, 240
  s_cselect_b32 s3, 1, s101
  s_xor_b32 s10, s26, 0
  s_or_b32 s3, s3, s10
  s_cbranch_scc1 sequential_preLN__mha_block__moe_arch_mod__prompt_kernel_f163
  s_mov_b64 exec, 0xff
  buffer_store_dword v177, v176, s[20:23], s8 offen sc1
  s_mov_b64 exec, -1
sequential_preLN__mha_block__moe_arch_mod__prompt_kernel_f163:
  s_mov_b32 s14, 819200
  s_mov_b32 s15, 0x20000
  s_mov_b32 s50, 2621440
  s_mov_b32 s51, 0x20000
  s_mov_b32 s18, 2211840
  s_mov_b32 s19, 0x20000
  s_mov_b32 s46, 2211840
  s_mov_b32 s47, 0x20000
  s_mov_b32 s6, 0
  s_mov_b32 s7, 0x20000
  s_cmp_ge_u32 s2, 216
  s_cselect_b32 s6, 0, s18
  v_mov_b32 v146, v158
  v_mul_u32_u24 v2, 2560, v157
  v_add3_u32 v149, v1, v2, 0
  v_add_u32 v149, 1024, v149
  v_lshlrev_b32 v2, 4, v157
  v_lshl_add_u32 v2, v156, 5, v2
  v_add_u32 v152, 1280, v2
  v_add_u32 v147, 61440, v146
  v_add_u32 v150, 61440, v149
  v_add_u32 v153, 61440, v152
  v_add_u32 v148, 122880, v146
  v_add_u32 v151, 122880, v149
  v_add_u32 v154, 122880, v152
  v_and_b32 v2, 27, v156
  v_cmp_eq_u32 vcc, 24, v2
  v_mov_b32 v2, 0x3f803f80
  s_nop 0
  v_cndmask_b32 v2, 0, v2, vcc
  v_mov_b32 v108, v2
  v_mov_b32 v109, v2
  v_mov_b32 v110, v2
  v_mov_b32 v111, v2
  v_mov_b32 v112, v2
  v_mov_b32 v113, v2
  v_mov_b32 v114, v2
  v_mov_b32 v115, v2
  v_mov_b32 v116, v2
  v_mov_b32 v117, v2
  v_mov_b32 v118, v2
  v_mov_b32 v119, v2
  v_mov_b32 v120, v2
  v_mov_b32 v121, v2
  v_mov_b32 v122, v2
  v_mov_b32 v123, v2
  v_mov_b32 v124, v2
  v_mov_b32 v125, v2
  v_mov_b32 v126, v2
  v_mov_b32 v127, v2
  v_mov_b32 v128, v2
  v_mov_b32 v129, v2
  v_mov_b32 v130, v2
  v_mov_b32 v131, v2
  v_mov_b32 v132, v2
  v_mov_b32 v133, v2
  v_mov_b32 v134, v2
  v_mov_b32 v135, v2
  v_mov_b32 v136, v2
  v_mov_b32 v137, v2
  v_mov_b32 v138, v2
  v_mov_b32 v139, v2
  s_mov_b32 s40, 0x000fffff
  s_mov_b32 s41, 0x000fffff
  s_mul_i32 s36, s27, 40960
  s_lshl_b32 s37, s24, 10
  s_add_u32 s36, s36, 13107200
  s_add_u32 s37, s37, s36
  v_mov_b32 v247, v158
  s_lshr_b32 s38, s24, 2
  s_add_u32 s38, s38, 32
  s_lshl_b32 s38, s38, 10
  s_add_u32 s38, s38, s36
  s_bfe_u32 s3, s24, 0x10001
  s_lshl_b32 s3, s3, 9
  s_add_u32 s38, s38, s3
  s_and_b32 s3, s24, 1
  s_lshl_b32 s3, s3, 3
  s_add_u32 s38, s38, s3
  v_add_u32 v2, 0, v155
  v_mul_u32_u24 v3, 6554, v2
  v_lshrrev_b32 v3, 16, v3
  v_mul_u32_u24 v4, 1120, v3
  v_lshl_add_u32 v168, v2, 4, v4
  v_add_u32 v2, 64, v155
  v_mul_u32_u24 v3, 6554, v2
  v_lshrrev_b32 v3, 16, v3
  v_mul_u32_u24 v4, 1120, v3
  v_lshl_add_u32 v169, v2, 4, v4
  v_add_u32 v2, 128, v155
  v_mul_u32_u24 v3, 6554, v2
  v_lshrrev_b32 v3, 16, v3
  v_mul_u32_u24 v4, 1120, v3
  v_lshl_add_u32 v170, v2, 4, v4
  v_add_u32 v2, 192, v155
  v_mul_u32_u24 v3, 6554, v2
  v_lshrrev_b32 v3, 16, v3
  v_mul_u32_u24 v4, 1120, v3
  v_lshl_add_u32 v171, v2, 4, v4
  v_add_u32 v2, 256, v155
  v_mul_u32_u24 v3, 6554, v2
  v_lshrrev_b32 v3, 16, v3
  v_mul_u32_u24 v4, 1120, v3
  v_lshl_add_u32 v172, v2, 4, v4
  s_mul_i32 s70, s26, 102400
  s_add_u32 s70, s70, s42
  s_add_u32 s71, s70, 40960
  s_add_u32 s72, s70, 81920
  s_mul_i32 s73, s26, 12800
  s_and_b32 s3, s2, 7
  s_mul_i32 s28, s3, 27
  s_lshr_b32 s29, s2, 3
  s_add_u32 s28, s28, s29
  s_mul_i32 s52, s28, 10240
  s_add_u32 s53, s52, 5120
  s_lshl_b32 s28, s28, 4
  s_mul_i32 s10, s3, 432
  s_andn2_b32 s10, s10, 63
  s_mul_i32 s11, s29, 69120
  s_add_u32 s10, s10, s11
  s_mul_i32 s3, s3, 5
  s_add_u32 s3, s3, s29
  s_sub_u32 s3, s3, 27
  s_lshl_b32 s3, s3, 5
  s_cmp_ge_u32 s2, 216
  s_cselect_b32 s74, s3, s28
  s_cselect_b32 s11, 0x40000000, 0
  v_mul_u32_u24 v173, 6912, v159
  v_add_u32 v173, s11, v173
  v_lshlrev_b32 v174, 2, v159
  v_lshrrev_b32 v2, 3, v159
  v_mul_u32_u24 v2, 3456, v2
  v_and_b32 v3, 7, v159
  v_lshl_add_u32 v2, v3, 6, v2
  v_mov_b32 v3, 160
  v_cmp_gt_u32 vcc, v3, v159
  v_mov_b32 v3, 0x40000000
  s_nop 0
  v_cndmask_b32 v175, v3, v2, vcc
  v_add_u32 v107, s31, v158
  v_add_u32 v161, 49152, v107
  v_lshlrev_b32 v162, 2, v156
  s_cmp_lg_u32 s26, 0
  s_cbranch_scc1 sequential_preLN__mha_block__moe_arch_mod__prompt_kernel_w064
  s_lshl_b32 s3, 0x0101, s25
  s_or_b32 exec_lo, s3, 0x0f0f0000
  s_mov_b32 exec_hi, 0x0f0f
sequential_preLN__mha_block__moe_arch_mod__prompt_kernel_poll65:
  buffer_load_dwordx2 v[4:5], v160, s[20:23], s9 offen sc1
  s_waitcnt vmcnt(0)
  v_max_u32 v4, v4, v5
  v_cmp_eq_u32 vcc, -1, v4
  s_nop 4
  s_cbranch_vccz sequential_preLN__mha_block__moe_arch_mod__prompt_kernel_ok66
  s_sub_u32 s75, s75, 1
  s_cbranch_scc1 sequential_preLN__mha_block__moe_arch_mod__prompt_kernel_end1
  s_branch sequential_preLN__mha_block__moe_arch_mod__prompt_kernel_poll65
sequential_preLN__mha_block__moe_arch_mod__prompt_kernel_ok66:
  s_mov_b64 exec, -1
sequential_preLN__mha_block__moe_arch_mod__prompt_kernel_w064:
  s_barrier
  s_add_u32 m0, s31, 0
  s_add_u32 s33, s32, 0
  buffer_load_dwordx4 v158, s[20:23], s33 offen sc1 lds
  buffer_load_dwordx4 v[140:143], v158, s[20:23], s39 offen sc1
  buffer_load_dwordx2 v[144:145], v1, s[20:23], s39 offen offset:1024 sc1
  s_add_u32 m0, s31, 8192
  s_add_u32 s33, s32, 8192
  buffer_load_dwordx4 v158, s[20:23], s33 offen sc1 lds
  s_add_u32 m0, s31, 16384
  s_add_u32 s33, s32, 16384
  buffer_load_dwordx4 v158, s[20:23], s33 offen sc1 lds
  s_add_u32 m0, s31, 24576
  s_add_u32 s33, s32, 24576
  buffer_load_dwordx4 v158, s[20:23], s33 offen sc1 lds
  s_add_u32 m0, s31, 32768
  s_add_u32 s33, s32, 32768
  buffer_load_dwordx4 v158, s[20:23], s33 offen sc1 lds
  s_add_u32 m0, s31, 40960
  s_add_u32 s33, s32, 40960
  buffer_load_dwordx4 v158, s[20:23], s33 offen sc1 lds
  s_waitcnt vmcnt(4)
  s_barrier
  ds_read_b128 v[96:99], v146 offset:0
  ds_read_b128 v[100:103], v146 offset:2560
  ds_read_b64 v[104:105], v149 offset:0
  s_waitcnt lgkmcnt(0)
  v_mfma_f32_32x32x16_bf16 v[0:15], v[96:99], v[140:143], 0
  v_mfma_f32_32x32x16_bf16 v[16:31], v[100:103], v[140:143], 0
  s_nop 9
  v_mfma_f32_32x32x4_2b_bf16 v[0:31], v[104:105], v[144:145], v[0:31]
  ds_read_b128 v[96:99], v146 offset:5120
  ds_read_b128 v[100:103], v146 offset:7680
  ds_read_b64 v[104:105], v149 offset:5120
  s_mov_b64 exec, s[40:41]
  ds_read_b128 v[108:111], v152 offset:0
  ds_read_b128 v[112:115], v152 offset:640
  ds_read_b128 v[116:119], v152 offset:2560
  ds_read_b128 v[120:123], v152 offset:3200
  s_mov_b64 exec, -1
  s_nop 10
  v_exp_f32 v0, v0
  v_exp_f32 v1, v1
  s_waitcnt lgkmcnt(0)
  v_exp_f32 v2, v2
  v_exp_f32 v3, v3
  v_exp_f32 v4, v4
  v_exp_f32 v5, v5
  v_mfma_f32_32x32x16_bf16 v[32:47], v[96:99], v[140:143], 0
  ds_read_b128 v[96:99], v146 offset:10240
  v_exp_f32 v6, v6
  v_exp_f32 v7, v7
  v_cvt_pk_bf16_f32 v64, v0, v1
  v_cvt_pk_bf16_f32 v65, v2, v3
  v_cvt_pk_bf16_f32 v66, v4, v5
  v_cvt_pk_bf16_f32 v67, v6, v7
  v_exp_f32 v8, v8
  v_mfma_f32_32x32x16_bf16 v[48:63], v[100:103], v[140:143], 0
  ds_read_b128 v[100:103], v146 offset:12800
  v_exp_f32 v9, v9
  v_exp_f32 v10, v10
  v_exp_f32 v11, v11
  v_exp_f32 v12, v12
  s_mov_b64 exec, s[40:41]
  v_mfma_f32_32x32x16_bf16 v[80:95], v[108:111], v[64:67], 0
  ds_read_b128 v[124:127], v152 offset:5120
  ds_read_b128 v[128:131], v152 offset:5760
  ds_read_b128 v[132:135], v152 offset:7680
  ds_read_b128 v[136:139], v152 offset:8320
  s_mov_b64 exec, -1
  v_exp_f32 v13, v13
  v_exp_f32 v14, v14
  v_exp_f32 v15, v15
  v_cvt_pk_bf16_f32 v68, v8, v9
  v_cvt_pk_bf16_f32 v69, v10, v11
  v_cvt_pk_bf16_f32 v70, v12, v13
  v_cvt_pk_bf16_f32 v71, v14, v15
  v_mfma_f32_32x32x4_2b_bf16 v[32:63], v[104:105], v[144:145], v[32:63]
  ds_read_b64 v[104:105], v149 offset:10240
  v_exp_f32 v16, v16
  v_exp_f32 v17, v17
  v_exp_f32 v18, v18
  v_exp_f32 v19, v19
  v_exp_f32 v20, v20
  v_exp_f32 v21, v21
  v_exp_f32 v22, v22
  v_exp_f32 v23, v23
  s_add_u32 m0, s31, 49152
  s_add_u32 s33, s32, 49152
  v_mfma_f32_32x32x16_bf16 v[80:95], v[112:115], v[68:71], v[80:95]
  buffer_load_dwordx4 v158, s[20:23], s33 offen sc1 lds
  v_cvt_pk_bf16_f32 v72, v16, v17
  v_cvt_pk_bf16_f32 v73, v18, v19
  v_cvt_pk_bf16_f32 v74, v20, v21
  v_cvt_pk_bf16_f32 v75, v22, v23
  v_exp_f32 v24, v24
  v_exp_f32 v25, v25
  s_add_u32 m0, s31, 57344
  s_add_u32 s33, s32, 57344
  v_mfma_f32_32x32x16_bf16 v[80:95], v[116:119], v[72:75], v[80:95]
  buffer_load_dwordx4 v158, s[20:23], s33 offen sc1 lds
  v_exp_f32 v26, v26
  v_exp_f32 v27, v27
  v_exp_f32 v28, v28
  v_exp_f32 v29, v29
  v_exp_f32 v30, v30
  v_exp_f32 v31, v31
  v_cvt_pk_bf16_f32 v76, v24, v25
  v_cvt_pk_bf16_f32 v77, v26, v27
  v_cvt_pk_bf16_f32 v78, v28, v29
  v_cvt_pk_bf16_f32 v79, v30, v31
  v_exp_f32 v32, v32
  v_exp_f32 v33, v33
  v_mfma_f32_32x32x16_bf16 v[80:95], v[120:123], v[76:79], v[80:95]
  s_waitcnt vmcnt(2) lgkmcnt(0)
  s_barrier
  s_cmp_eq_u32 s101, 0
  s_cbranch_scc1 sequential_preLN__mha_block__moe_arch_mod__prompt_kernel_ld68
  s_cmp_eq_u32 s101, 2
  s_cbranch_scc1 sequential_preLN__mha_block__moe_arch_mod__prompt_kernel_lv67
  s_mov_b32 s3, 163840
  v_cmp_ne_u32 vcc, v208, v212
  buffer_store_dwordx4 v[190:193], v212, s[20:23], 0 offen sc1
  s_nop 3
  s_cbranch_vccz sequential_preLN__mha_block__moe_arch_mod__prompt_kernel_ls69
  buffer_store_dwordx2 v[190:191], v216, s[20:23], 0 offen sc1
  buffer_store_dwordx2 v[192:193], v216, s[20:23], s3 offen sc1
sequential_preLN__mha_block__moe_arch_mod__prompt_kernel_ls69:
  s_branch sequential_preLN__mha_block__moe_arch_mod__prompt_kernel_ld68
sequential_preLN__mha_block__moe_arch_mod__prompt_kernel_lv67:
  buffer_store_dwordx4 v[190:193], v208, s[20:23], 0 offen sc1
sequential_preLN__mha_block__moe_arch_mod__prompt_kernel_ld68:
  v_exp_f32 v34, v34
  v_exp_f32 v35, v35
  v_exp_f32 v36, v36
  v_exp_f32 v37, v37
  v_mfma_f32_32x32x16_bf16 v[0:15], v[96:99], v[140:143], 0
  ds_read_b128 v[96:99], v146 offset:15360
  v_exp_f32 v38, v38
  v_exp_f32 v39, v39
  v_cvt_pk_bf16_f32 v64, v32, v33
  v_cvt_pk_bf16_f32 v65, v34, v35
  v_cvt_pk_bf16_f32 v66, v36, v37
  v_cvt_pk_bf16_f32 v67, v38, v39
  v_exp_f32 v40, v40
  v_mfma_f32_32x32x16_bf16 v[16:31], v[100:103], v[140:143], 0
  ds_read_b128 v[100:103], v146 offset:17920
  v_exp_f32 v41, v41
  v_exp_f32 v42, v42
  v_exp_f32 v43, v43
  v_exp_f32 v44, v44
  s_mov_b64 exec, s[40:41]
  v_mfma_f32_32x32x16_bf16 v[80:95], v[124:127], v[64:67], v[80:95]
  ds_read_b128 v[108:111], v152 offset:10240
  ds_read_b128 v[112:115], v152 offset:10880
  ds_read_b128 v[116:119], v152 offset:12800
  ds_read_b128 v[120:123], v152 offset:13440
  s_mov_b64 exec, -1
  v_exp_f32 v45, v45
  v_exp_f32 v46, v46
  v_exp_f32 v47, v47
  v_cvt_pk_bf16_f32 v68, v40, v41
  v_cvt_pk_bf16_f32 v69, v42, v43
  v_cvt_pk_bf16_f32 v70, v44, v45
  v_cvt_pk_bf16_f32 v71, v46, v47
  v_mfma_f32_32x32x4_2b_bf16 v[0:31], v[104:105], v[144:145], v[0:31]
  ds_read_b64 v[104:105], v149 offset:15360
  s_cmp_eq_u32 s101, 0
  s_cbranch_scc1 sequential_preLN__mha_block__moe_arch_mod__prompt_kernel_ld71
  s_cmp_eq_u32 s101, 2
  s_cbranch_scc1 sequential_preLN__mha_block__moe_arch_mod__prompt_kernel_lv70
  s_mov_b32 s3, 163840
  v_cmp_ne_u32 vcc, v209, v213
  buffer_store_dwordx4 v[194:197], v213, s[20:23], 0 offen sc1
  s_nop 3
  s_cbranch_vccz sequential_preLN__mha_block__moe_arch_mod__prompt_kernel_ls72
  buffer_store_dwordx2 v[194:195], v217, s[20:23], 0 offen sc1
  buffer_store_dwordx2 v[196:197], v217, s[20:23], s3 offen sc1
sequential_preLN__mha_block__moe_arch_mod__prompt_kernel_ls72:
  s_branch sequential_preLN__mha_block__moe_arch_mod__prompt_kernel_ld71
sequential_preLN__mha_block__moe_arch_mod__prompt_kernel_lv70:
  buffer_store_dwordx4 v[194:197], v209, s[20:23], 0 offen sc1
sequential_preLN__mha_block__moe_arch_mod__prompt_kernel_ld71:
  v_exp_f32 v48, v48
  v_exp_f32 v49, v49
  v_exp_f32 v50, v50
  v_exp_f32 v51, v51
  v_exp_f32 v52, v52
  v_exp_f32 v53, v53
  v_exp_f32 v54, v54
  v_exp_f32 v55, v55
  s_add_u32 m0, s31, 65536
  s_add_u32 s33, s32, 65536
  v_mfma_f32_32x32x16_bf16 v[80:95], v[128:131], v[68:71], v[80:95]
  buffer_load_dwordx4 v158, s[20:23], s33 offen sc1 lds
  v_cvt_pk_bf16_f32 v72, v48, v49
  v_cvt_pk_bf16_f32 v73, v50, v51
  v_cvt_pk_bf16_f32 v74, v52, v53
  v_cvt_pk_bf16_f32 v75, v54, v55
  v_exp_f32 v56, v56
  v_exp_f32 v57, v57
  s_add_u32 m0, s31, 73728
  s_add_u32 s33, s32, 73728
  v_mfma_f32_32x32x16_bf16 v[80:95], v[132:135], v[72:75], v[80:95]
  buffer_load_dwordx4 v158, s[20:23], s33 offen sc1 lds
  v_exp_f32 v58, v58
  v_exp_f32 v59, v59
  v_exp_f32 v60, v60
  v_exp_f32 v61, v61
  v_exp_f32 v62, v62
  v_exp_f32 v63, v63
  v_cvt_pk_bf16_f32 v76, v56, v57
  v_cvt_pk_bf16_f32 v77, v58, v59
  v_cvt_pk_bf16_f32 v78, v60, v61
  v_cvt_pk_bf16_f32 v79, v62, v63
  v_exp_f32 v0, v0
  v_exp_f32 v1, v1
  v_mfma_f32_32x32x16_bf16 v[80:95], v[136:139], v[76:79], v[80:95]
  s_waitcnt lgkmcnt(0)
  s_cmp_eq_u32 s101, 0
  s_cbranch_scc1 sequential_preLN__mha_block__moe_arch_mod__prompt_kernel_ld74
  s_cmp_eq_u32 s101, 2
  s_cbranch_scc1 sequential_preLN__mha_block__moe_arch_mod__prompt_kernel_lv73
  s_mov_b32 s3, 163840
  v_cmp_ne_u32 vcc, v210, v214
  buffer_store_dwordx4 v[198:201], v214, s[20:23], 0 offen sc1
  s_nop 3
  s_cbranch_vccz sequential_preLN__mha_block__moe_arch_mod__prompt_kernel_ls75
  buffer_store_dwordx2 v[198:199], v218, s[20:23], 0 offen sc1
  buffer_store_dwordx2 v[200:201], v218, s[20:23], s3 offen sc1
sequential_preLN__mha_block__moe_arch_mod__prompt_kernel_ls75:
  s_branch sequential_preLN__mha_block__moe_arch_mod__prompt_kernel_ld74
sequential_preLN__mha_block__moe_arch_mod__prompt_kernel_lv73:
  buffer_store_dwordx4 v[198:201], v210, s[20:23], 0 offen sc1
sequential_preLN__mha_block__moe_arch_mod__prompt_kernel_ld74:
  v_exp_f32 v2, v2
  v_exp_f32 v3, v3
  v_exp_f32 v4, v4
  v_exp_f32 v5, v5
  v_mfma_f32_32x32x16_bf16 v[32:47], v[96:99], v[140:143], 0
  ds_read_b128 v[96:99], v146 offset:20480
  v_exp_f32 v6, v6
  v_exp_f32 v7, v7
  v_cvt_pk_bf16_f32 v64, v0, v1
  v_cvt_pk_bf16_f32 v65, v2, v3
  v_cvt_pk_bf16_f32 v66, v4, v5
  v_cvt_pk_bf16_f32 v67, v6, v7
  v_exp_f32 v8, v8
  v_mfma_f32_32x32x16_bf16 v[48:63], v[100:103], v[140:143], 0
  ds_read_b128 v[100:103], v146 offset:23040
  v_exp_f32 v9, v9
  v_exp_f32 v10, v10
  v_exp_f32 v11, v11
  v_exp_f32 v12, v12
  s_mov_b64 exec, s[40:41]
  v_mfma_f32_32x32x16_bf16 v[80:95], v[108:111], v[64:67], v[80:95]
  ds_read_b128 v[124:127], v152 offset:15360
  ds_read_b128 v[128:131], v152 offset:16000
  ds_read_b128 v[132:135], v152 offset:17920
  ds_read_b128 v[136:139], v152 offset:18560
  s_mov_b64 exec, -1
  v_exp_f32 v13, v13
  v_exp_f32 v14, v14
  v_exp_f32 v15, v15
  v_cvt_pk_bf16_f32 v68, v8, v9
  v_cvt_pk_bf16_f32 v69, v10, v11
  v_cvt_pk_bf16_f32 v70, v12, v13
  v_cvt_pk_bf16_f32 v71, v14, v15
  v_mfma_f32_32x32x4_2b_bf16 v[32:63], v[104:105], v[144:145], v[32:63]
  ds_read_b64 v[104:105], v149 offset:20480
  s_cmp_eq_u32 s101, 0
  s_cbranch_scc1 sequential_preLN__mha_block__moe_arch_mod__prompt_kernel_ld77
  s_cmp_eq_u32 s101, 2
  s_cbranch_scc1 sequential_preLN__mha_block__moe_arch_mod__prompt_kernel_lv76
  s_mov_b32 s3, 163840
  v_cmp_ne_u32 vcc, v211, v215
  buffer_store_dwordx4 v[202:205], v215, s[20:23], 0 offen sc1
  s_nop 3
  s_cbranch_vccz sequential_preLN__mha_block__moe_arch_mod__prompt_kernel_ls78
  buffer_store_dwordx2 v[202:203], v219, s[20:23], 0 offen sc1
  buffer_store_dwordx2 v[204:205], v219, s[20:23], s3 offen sc1
sequential_preLN__mha_block__moe_arch_mod__prompt_kernel_ls78:
  s_branch sequential_preLN__mha_block__moe_arch_mod__prompt_kernel_ld77
sequential_preLN__mha_block__moe_arch_mod__prompt_kernel_lv76:
  buffer_store_dwordx4 v[202:205], v211, s[20:23], 0 offen sc1
sequential_preLN__mha_block__moe_arch_mod__prompt_kernel_ld77:
  v_exp_f32 v16, v16
  v_exp_f32 v17, v17
  v_exp_f32 v18, v18
  v_exp_f32 v19, v19
  v_exp_f32 v20, v20
  v_exp_f32 v21, v21
  v_exp_f32 v22, v22
  v_exp_f32 v23, v23
  v_mfma_f32_32x32x16_bf16 v[80:95], v[112:115], v[68:71], v[80:95]
  v_cvt_pk_bf16_f32 v72, v16, v17
  v_cvt_pk_bf16_f32 v73, v18, v19
  v_cvt_pk_bf16_f32 v74, v20, v21
  v_cvt_pk_bf16_f32 v75, v22, v23
  v_exp_f32 v24, v24
  v_exp_f32 v25, v25
  v_mfma_f32_32x32x16_bf16 v[80:95], v[116:119], v[72:75], v[80:95]
  v_exp_f32 v26, v26
  v_exp_f32 v27, v27
  v_exp_f32 v28, v28
  v_exp_f32 v29, v29
  v_exp_f32 v30, v30
  v_exp_f32 v31, v31
  v_cvt_pk_bf16_f32 v76, v24, v25
  v_cvt_pk_bf16_f32 v77, v26, v27
  v_cvt_pk_bf16_f32 v78, v28, v29
  v_cvt_pk_bf16_f32 v79, v30, v31
  v_exp_f32 v32, v32
  v_exp_f32 v33, v33
  v_mfma_f32_32x32x16_bf16 v[80:95], v[120:123], v[76:79], v[80:95]
  s_waitcnt lgkmcnt(0)
  v_exp_f32 v34, v34
  v_exp_f32 v35, v35
  v_exp_f32 v36, v36
  v_exp_f32 v37, v37
  v_mfma_f32_32x32x16_bf16 v[0:15], v[96:99], v[140:143], 0
  ds_read_b128 v[96:99], v146 offset:25600
  v_exp_f32 v38, v38
  v_exp_f32 v39, v39
  v_cvt_pk_bf16_f32 v64, v32, v33
  v_cvt_pk_bf16_f32 v65, v34, v35
  v_cvt_pk_bf16_f32 v66, v36, v37
  v_cvt_pk_bf16_f32 v67, v38, v39
  v_exp_f32 v40, v40
  v_mfma_f32_32x32x16_bf16 v[16:31], v[100:103], v[140:143], 0
  ds_read_b128 v[100:103], v146 offset:28160
  v_exp_f32 v41, v41
  v_exp_f32 v42, v42
  v_exp_f32 v43, v43
  v_exp_f32 v44, v44
  s_mov_b64 exec, s[40:41]
  v_mfma_f32_32x32x16_bf16 v[80:95], v[124:127], v[64:67], v[80:95]
  ds_read_b128 v[108:111], v152 offset:20480
  ds_read_b128 v[112:115], v152 offset:21120
  ds_read_b128 v[116:119], v152 offset:23040
  ds_read_b128 v[120:123], v152 offset:23680
  s_mov_b64 exec, -1
  v_exp_f32 v45, v45
  v_exp_f32 v46, v46
  v_exp_f32 v47, v47
  v_cvt_pk_bf16_f32 v68, v40, v41
  v_cvt_pk_bf16_f32 v69, v42, v43
  v_cvt_pk_bf16_f32 v70, v44, v45
  v_cvt_pk_bf16_f32 v71, v46, v47
  v_mfma_f32_32x32x4_2b_bf16 v[0:31], v[104:105], v[144:145], v[0:31]
  ds_read_b64 v[104:105], v149 offset:25600
  v_exp_f32 v48, v48
  v_exp_f32 v49, v49
  v_exp_f32 v50, v50
  v_exp_f32 v51, v51
  v_exp_f32 v52, v52
  v_exp_f32 v53, v53
  v_exp_f32 v54, v54
  v_exp_f32 v55, v55
  v_mfma_f32_32x32x16_bf16 v[80:95], v[128:131], v[68:71], v[80:95]
  buffer_load_dword v206, v175, s[16:19], s10 offen
  v_cvt_pk_bf16_f32 v72, v48, v49
  v_cvt_pk_bf16_f32 v73, v50, v51
  v_cvt_pk_bf16_f32 v74, v52, v53
  v_cvt_pk_bf16_f32 v75, v54, v55
  v_exp_f32 v56, v56
  v_exp_f32 v57, v57
  v_mfma_f32_32x32x16_bf16 v[80:95], v[132:135], v[72:75], v[80:95]
  buffer_load_dword v207, v175, s[44:47], s10 offen
  v_exp_f32 v58, v58
  v_exp_f32 v59, v59
  v_exp_f32 v60, v60
  v_exp_f32 v61, v61
  v_exp_f32 v62, v62
  v_exp_f32 v63, v63
  v_cvt_pk_bf16_f32 v76, v56, v57
  v_cvt_pk_bf16_f32 v77, v58, v59
  v_cvt_pk_bf16_f32 v78, v60, v61
  v_cvt_pk_bf16_f32 v79, v62, v63
  v_exp_f32 v0, v0
  v_exp_f32 v1, v1
  v_mfma_f32_32x32x16_bf16 v[80:95], v[136:139], v[76:79], v[80:95]
  s_waitcnt lgkmcnt(0)
  v_exp_f32 v2, v2
  v_exp_f32 v3, v3
  v_exp_f32 v4, v4
  v_exp_f32 v5, v5
  v_mfma_f32_32x32x16_bf16 v[32:47], v[96:99], v[140:143], 0
  ds_read_b128 v[96:99], v146 offset:30720
  v_exp_f32 v6, v6
  v_exp_f32 v7, v7
  v_cvt_pk_bf16_f32 v64, v0, v1
  v_cvt_pk_bf16_f32 v65, v2, v3
  v_cvt_pk_bf16_f32 v66, v4, v5
  v_cvt_pk_bf16_f32 v67, v6, v7
  v_exp_f32 v8, v8
  v_mfma_f32_32x32x16_bf16 v[48:63], v[100:103], v[140:143], 0
  ds_read_b128 v[100:103], v146 offset:33280
  v_exp_f32 v9, v9
  v_exp_f32 v10, v10
  v_exp_f32 v11, v11
  v_exp_f32 v12, v12
  s_mov_b64 exec, s[40:41]
  v_mfma_f32_32x32x16_bf16 v[80:95], v[108:111], v[64:67], v[80:95]
  ds_read_b128 v[124:127], v152 offset:25600
  ds_read_b128 v[128:131], v152 offset:26240
  ds_read_b128 v[132:135], v152 offset:28160
  ds_read_b128 v[136:139], v152 offset:28800
  s_mov_b64 exec, -1
  v_exp_f32 v13, v13
  v_exp_f32 v14, v14
  v_exp_f32 v15, v15
  v_cvt_pk_bf16_f32 v68, v8, v9
  v_cvt_pk_bf16_f32 v69, v10, v11
  v_cvt_pk_bf16_f32 v70, v12, v13
  v_cvt_pk_bf16_f32 v71, v14, v15
  v_mfma_f32_32x32x4_2b_bf16 v[32:63], v[104:105], v[144:145], v[32:63]
  ds_read_b64 v[104:105], v149 offset:30720
  v_exp_f32 v16, v16
  v_exp_f32 v17, v17
  v_exp_f32 v18, v18
  v_exp_f32 v19, v19
  v_exp_f32 v20, v20
  v_exp_f32 v21, v21
  v_exp_f32 v22, v22
  v_exp_f32 v23, v23
  v_mfma_f32_32x32x16_bf16 v[80:95], v[112:115], v[68:71], v[80:95]
  v_cvt_pk_bf16_f32 v72, v16, v17
  v_cvt_pk_bf16_f32 v73, v18, v19
  v_cvt_pk_bf16_f32 v74, v20, v21
  v_cvt_pk_bf16_f32 v75, v22, v23
  v_exp_f32 v24, v24
  v_exp_f32 v25, v25
  v_mfma_f32_32x32x16_bf16 v[80:95], v[116:119], v[72:75], v[80:95]
  v_exp_f32 v26, v26
  v_exp_f32 v27, v27
  v_exp_f32 v28, v28
  v_exp_f32 v29, v29
  v_exp_f32 v30, v30
  v_exp_f32 v31, v31
  v_cvt_pk_bf16_f32 v76, v24, v25
  v_cvt_pk_bf16_f32 v77, v26, v27
  v_cvt_pk_bf16_f32 v78, v28, v29
  v_cvt_pk_bf16_f32 v79, v30, v31
  v_exp_f32 v32, v32
  v_exp_f32 v33, v33
  v_mfma_f32_32x32x16_bf16 v[80:95], v[120:123], v[76:79], v[80:95]
  s_waitcnt lgkmcnt(0)
  v_exp_f32 v34, v34
  v_exp_f32 v35, v35
  v_exp_f32 v36, v36
  v_exp_f32 v37, v37
  v_mfma_f32_32x32x16_bf16 v[0:15], v[96:99], v[140:143], 0
  ds_read_b128 v[96:99], v146 offset:35840
  v_exp_f32 v38, v38
  v_exp_f32 v39, v39
  v_cvt_pk_bf16_f32 v64, v32, v33
  v_cvt_pk_bf16_f32 v65, v34, v35
  v_cvt_pk_bf16_f32 v66, v36, v37
  v_cvt_pk_bf16_f32 v67, v38, v39
  v_exp_f32 v40, v40
  v_mfma_f32_32x32x16_bf16 v[16:31], v[100:103], v[140:143], 0
  ds_read_b128 v[100:103], v146 offset:38400
  v_exp_f32 v41, v41
  v_exp_f32 v42, v42
  v_exp_f32 v43, v43
  v_exp_f32 v44, v44
  s_mov_b64 exec, s[40:41]
  v_mfma_f32_32x32x16_bf16 v[80:95], v[124:127], v[64:67], v[80:95]
  ds_read_b128 v[108:111], v152 offset:30720
  ds_read_b128 v[112:115], v152 offset:31360
  ds_read_b128 v[116:119], v152 offset:33280
  ds_read_b128 v[120:123], v152 offset:33920
  s_mov_b64 exec, -1
  v_exp_f32 v45, v45
  v_exp_f32 v46, v46
  v_exp_f32 v47, v47
  v_cvt_pk_bf16_f32 v68, v40, v41
  v_cvt_pk_bf16_f32 v69, v42, v43
  v_cvt_pk_bf16_f32 v70, v44, v45
  v_cvt_pk_bf16_f32 v71, v46, v47
  v_mfma_f32_32x32x4_2b_bf16 v[0:31], v[104:105], v[144:145], v[0:31]
  ds_read_b64 v[104:105], v149 offset:35840
  v_exp_f32 v48, v48
  v_exp_f32 v49, v49
  v_exp_f32 v50, v50
  v_exp_f32 v51, v51
  v_exp_f32 v52, v52
  v_exp_f32 v53, v53
  v_exp_f32 v54, v54
  v_exp_f32 v55, v55
  v_mfma_f32_32x32x16_bf16 v[80:95], v[128:131], v[68:71], v[80:95]
  v_cvt_pk_bf16_f32 v72, v48, v49
  v_cvt_pk_bf16_f32 v73, v50, v51
  v_cvt_pk_bf16_f32 v74, v52, v53
  v_cvt_pk_bf16_f32 v75, v54, v55
  v_exp_f32 v56, v56
  v_exp_f32 v57, v57
  v_mfma_f32_32x32x16_bf16 v[80:95], v[132:135], v[72:75], v[80:95]
  v_exp_f32 v58, v58
  v_exp_f32 v59, v59
  v_exp_f32 v60, v60
  v_exp_f32 v61, v61
  v_exp_f32 v62, v62
  v_exp_f32 v63, v63
  v_cvt_pk_bf16_f32 v76, v56, v57
  v_cvt_pk_bf16_f32 v77, v58, v59
  v_cvt_pk_bf16_f32 v78, v60, v61
  v_cvt_pk_bf16_f32 v79, v62, v63
  v_exp_f32 v0, v0
  v_exp_f32 v1, v1
  v_mfma_f32_32x32x16_bf16 v[80:95], v[136:139], v[76:79], v[80:95]
  s_waitcnt lgkmcnt(0)
  v_exp_f32 v2, v2
  v_exp_f32 v3, v3
  v_exp_f32 v4, v4
  v_exp_f32 v5, v5
  v_mfma_f32_32x32x16_bf16 v[32:47], v[96:99], v[140:143], 0
  ds_read_b128 v[96:99], v146 offset:40960
  v_exp_f32 v6, v6
  v_exp_f32 v7, v7
  v_cvt_pk_bf16_f32 v64, v0, v1
  v_cvt_pk_bf16_f32 v65, v2, v3
  v_cvt_pk_bf16_f32 v66, v4, v5
  v_cvt_pk_bf16_f32 v67, v6, v7
  v_exp_f32 v8, v8
  v_mfma_f32_32x32x16_bf16 v[48:63], v[100:103], v[140:143], 0
  ds_read_b128 v[100:103], v146 offset:43520
  v_exp_f32 v9, v9
  v_exp_f32 v10, v10
  v_exp_f32 v11, v11
  v_exp_f32 v12, v12
  s_mov_b64 exec, s[40:41]
  v_mfma_f32_32x32x16_bf16 v[80:95], v[108:111], v[64:67], v[80:95]
  ds_read_b128 v[124:127], v152 offset:35840
  ds_read_b128 v[128:131], v152 offset:36480
  ds_read_b128 v[132:135], v152 offset:38400
  ds_read_b128 v[136:139], v152 offset:39040
  s_mov_b64 exec, -1
  v_exp_f32 v13, v13
  v_exp_f32 v14, v14
  v_exp_f32 v15, v15
  v_cvt_pk_bf16_f32 v68, v8, v9
  v_cvt_pk_bf16_f32 v69, v10, v11
  v_cvt_pk_bf16_f32 v70, v12, v13
  v_cvt_pk_bf16_f32 v71, v14, v15
  v_mfma_f32_32x32x4_2b_bf16 v[32:63], v[104:105], v[144:145], v[32:63]
  ds_read_b64 v[104:105], v149 offset:40960
  v_exp_f32 v16, v16
  v_exp_f32 v17, v17
  v_exp_f32 v18, v18
  v_exp_f32 v19, v19
  v_exp_f32 v20, v20
  v_exp_f32 v21, v21
  v_exp_f32 v22, v22
  v_exp_f32 v23, v23
  v_mfma_f32_32x32x16_bf16 v[80:95], v[112:115], v[68:71], v[80:95]
  v_cvt_pk_bf16_f32 v72, v16, v17
  v_cvt_pk_bf16_f32 v73, v18, v19
  v_cvt_pk_bf16_f32 v74, v20, v21
  v_cvt_pk_bf16_f32 v75, v22, v23
  v_exp_f32 v24, v24
  v_exp_f32 v25, v25
  v_mfma_f32_32x32x16_bf16 v[80:95], v[116:119], v[72:75], v[80:95]
  v_exp_f32 v26, v26
  v_exp_f32 v27, v27
  v_exp_f32 v28, v28
  v_exp_f32 v29, v29
  v_exp_f32 v30, v30
  v_exp_f32 v31, v31
  v_cvt_pk_bf16_f32 v76, v24, v25
  v_cvt_pk_bf16_f32 v77, v26, v27
  v_cvt_pk_bf16_f32 v78, v28, v29
  v_cvt_pk_bf16_f32 v79, v30, v31
  v_exp_f32 v32, v32
  v_exp_f32 v33, v33
  v_mfma_f32_32x32x16_bf16 v[80:95], v[120:123], v[76:79], v[80:95]
  s_waitcnt vmcnt(2) lgkmcnt(0)
  s_barrier
  s_cmp_eq_u32 s26, 2
  s_cselect_b32 s3, s101, 0
  s_cmp_eq_u32 s3, 0
  s_cbranch_scc1 sequential_preLN__mha_block__moe_arch_mod__prompt_kernel_lr79
  s_mov_b64 exec, 0xff
  buffer_store_dword v177, v176, s[20:23], s8 offen offset:64 sc1
  s_mov_b64 exec, -1
sequential_preLN__mha_block__moe_arch_mod__prompt_kernel_lr79:
  v_exp_f32 v34, v34
  v_exp_f32 v35, v35
  v_exp_f32 v36, v36
  v_exp_f32 v37, v37
  v_mfma_f32_32x32x16_bf16 v[0:15], v[96:99], v[140:143], 0
  ds_read_b128 v[96:99], v146 offset:46080
  v_exp_f32 v38, v38
  v_exp_f32 v39, v39
  v_cvt_pk_bf16_f32 v64, v32, v33
  v_cvt_pk_bf16_f32 v65, v34, v35
  v_cvt_pk_bf16_f32 v66, v36, v37
  v_cvt_pk_bf16_f32 v67, v38, v39
  v_exp_f32 v40, v40
  v_mfma_f32_32x32x16_bf16 v[16:31], v[100:103], v[140:143], 0
  ds_read_b128 v[100:103], v146 offset:48640
  v_exp_f32 v41, v41
  v_exp_f32 v42, v42
  v_exp_f32 v43, v43
  v_exp_f32 v44, v44
  s_mov_b64 exec, s[40:41]
  v_mfma_f32_32x32x16_bf16 v[80:95], v[124:127], v[64:67], v[80:95]
  ds_read_b128 v[108:111], v152 offset:40960
  ds_read_b128 v[112:115], v152 offset:41600
  ds_read_b128 v[116:119], v152 offset:43520
  ds_read_b128 v[120:123], v152 offset:44160
  s_mov_b64 exec, -1
  v_exp_f32 v45, v45
  v_exp_f32 v46, v46
  v_exp_f32 v47, v47
  v_cvt_pk_bf16_f32 v68, v40, v41
  v_cvt_pk_bf16_f32 v69, v42, v43
  v_cvt_pk_bf16_f32 v70, v44, v45
  v_cvt_pk_bf16_f32 v71, v46, v47
  v_mfma_f32_32x32x4_2b_bf16 v[0:31], v[104:105], v[144:145], v[0:31]
  ds_read_b64 v[104:105], v149 offset:46080
  v_exp_f32 v48, v48
  v_exp_f32 v49, v49
  v_exp_f32 v50, v50
  v_exp_f32 v51, v51
  v_exp_f32 v52, v52
  v_exp_f32 v53, v53
  v_exp_f32 v54, v54
  v_exp_f32 v55, v55
  v_mfma_f32_32x32x16_bf16 v[80:95], v[128:131], v[68:71], v[80:95]
  v_cvt_pk_bf16_f32 v72, v48, v49
  v_cvt_pk_bf16_f32 v73, v50, v51
  v_cvt_pk_bf16_f32 v74, v52, v53
  v_cvt_pk_bf16_f32 v75, v54, v55
  v_exp_f32 v56, v56
  v_exp_f32 v57, v57
  v_mfma_f32_32x32x16_bf16 v[80:95], v[132:135], v[72:75], v[80:95]
  v_exp_f32 v58, v58
  v_exp_f32 v59, v59
  v_exp_f32 v60, v60
  v_exp_f32 v61, v61
  v_exp_f32 v62, v62
  v_exp_f32 v63, v63
  v_cvt_pk_bf16_f32 v76, v56, v57
  v_cvt_pk_bf16_f32 v77, v58, v59
  v_cvt_pk_bf16_f32 v78, v60, v61
  v_cvt_pk_bf16_f32 v79, v62, v63
  v_exp_f32 v0, v0
  v_exp_f32 v1, v1
  v_mfma_f32_32x32x16_bf16 v[80:95], v[136:139], v[76:79], v[80:95]
  s_waitcnt lgkmcnt(0)
  v_exp_f32 v2, v2
  v_exp_f32 v3, v3
  v_exp_f32 v4, v4
  v_exp_f32 v5, v5
  v_mfma_f32_32x32x16_bf16 v[32:47], v[96:99], v[140:143], 0
  ds_read_b128 v[96:99], v146 offset:51200
  v_exp_f32 v6, v6
  v_exp_f32 v7, v7
  v_cvt_pk_bf16_f32 v64, v0, v1
  v_cvt_pk_bf16_f32 v65, v2, v3
  v_cvt_pk_bf16_f32 v66, v4, v5
  v_cvt_pk_bf16_f32 v67, v6, v7
  v_exp_f32 v8, v8
  v_mfma_f32_32x32x16_bf16 v[48:63], v[100:103], v[140:143], 0
  ds_read_b128 v[100:103], v146 offset:53760
  v_exp_f32 v9, v9
  v_exp_f32 v10, v10
  v_exp_f32 v11, v11
  v_exp_f32 v12, v12
  s_mov_b64 exec, s[40:41]
  v_mfma_f32_32x32x16_bf16 v[80:95], v[108:111], v[64:67], v[80:95]
  ds_read_b128 v[124:127], v152 offset:46080
  ds_read_b128 v[128:131], v152 offset:46720
  ds_read_b128 v[132:135], v152 offset:48640
  ds_read_b128 v[136:139], v152 offset:49280
  s_mov_b64 exec, -1
  v_exp_f32 v13, v13
  v_exp_f32 v14, v14
  v_exp_f32 v15, v15
  v_cvt_pk_bf16_f32 v68, v8, v9
  v_cvt_pk_bf16_f32 v69, v10, v11
  v_cvt_pk_bf16_f32 v70, v12, v13
  v_cvt_pk_bf16_f32 v71, v14, v15
  v_mfma_f32_32x32x4_2b_bf16 v[32:63], v[104:105], v[144:145], v[32:63]
  ds_read_b64 v[104:105], v149 offset:51200
  v_exp_f32 v16, v16
  v_exp_f32 v17, v17
  v_exp_f32 v18, v18
  v_exp_f32 v19, v19
  v_exp_f32 v20, v20
  v_exp_f32 v21, v21
  v_exp_f32 v22, v22
  v_exp_f32 v23, v23
  v_mfma_f32_32x32x16_bf16 v[80:95], v[112:115], v[68:71], v[80:95]
  v_cvt_pk_bf16_f32 v72, v16, v17
  v_cvt_pk_bf16_f32 v73, v18, v19
  v_cvt_pk_bf16_f32 v74, v20, v21
  v_cvt_pk_bf16_f32 v75, v22, v23
  v_exp_f32 v24, v24
  v_exp_f32 v25, v25
  v_mfma_f32_32x32x16_bf16 v[80:95], v[116:119], v[72:75], v[80:95]
  v_exp_f32 v26, v26
  v_exp_f32 v27, v27
  v_exp_f32 v28, v28
  v_exp_f32 v29, v29
  v_exp_f32 v30, v30
  v_exp_f32 v31, v31
  v_cvt_pk_bf16_f32 v76, v24, v25
  v_cvt_pk_bf16_f32 v77, v26, v27
  v_cvt_pk_bf16_f32 v78, v28, v29
  v_cvt_pk_bf16_f32 v79, v30, v31
  v_exp_f32 v32, v32
  v_exp_f32 v33, v33
  v_mfma_f32_32x32x16_bf16 v[80:95], v[120:123], v[76:79], v[80:95]
  s_waitcnt lgkmcnt(0)
  v_exp_f32 v34, v34
  v_exp_f32 v35, v35
  v_exp_f32 v36, v36
  v_exp_f32 v37, v37
  v_mfma_f32_32x32x16_bf16 v[0:15], v[96:99], v[140:143], 0
  ds_read_b128 v[96:99], v146 offset:56320
  v_exp_f32 v38, v38
  v_exp_f32 v39, v39
  v_cvt_pk_bf16_f32 v64, v32, v33
  v_cvt_pk_bf16_f32 v65, v34, v35
  v_cvt_pk_bf16_f32 v66, v36, v37
  v_cvt_pk_bf16_f32 v67, v38, v39
  v_exp_f32 v40, v40
  v_mfma_f32_32x32x16_bf16 v[16:31], v[100:103], v[140:143], 0
  ds_read_b128 v[100:103], v146 offset:58880
  v_exp_f32 v41, v41
  v_exp_f32 v42, v42
  v_exp_f32 v43, v43
  v_exp_f32 v44, v44
  s_mov_b64 exec, s[40:41]
  v_mfma_f32_32x32x16_bf16 v[80:95], v[124:127], v[64:67], v[80:95]
  ds_read_b128 v[108:111], v152 offset:51200
  ds_read_b128 v[112:115], v152 offset:51840
  ds_read_b128 v[116:119], v152 offset:53760
  ds_read_b128 v[120:123], v152 offset:54400
  s_mov_b64 exec, -1
  v_exp_f32 v45, v45
  v_exp_f32 v46, v46
  v_exp_f32 v47, v47
  v_cvt_pk_bf16_f32 v68, v40, v41
  v_cvt_pk_bf16_f32 v69, v42, v43
  v_cvt_pk_bf16_f32 v70, v44, v45
  v_cvt_pk_bf16_f32 v71, v46, v47
  v_mfma_f32_32x32x4_2b_bf16 v[0:31], v[104:105], v[144:145], v[0:31]
  ds_read_b64 v[104:105], v149 offset:56320
  v_exp_f32 v48, v48
  v_exp_f32 v49, v49
  v_exp_f32 v50, v50
  v_exp_f32 v51, v51
  v_exp_f32 v52, v52
  v_exp_f32 v53, v53
  v_exp_f32 v54, v54
  v_exp_f32 v55, v55
  v_mfma_f32_32x32x16_bf16 v[80:95], v[128:131], v[68:71], v[80:95]
  v_cvt_pk_bf16_f32 v72, v48, v49
  v_cvt_pk_bf16_f32 v73, v50, v51
  v_cvt_pk_bf16_f32 v74, v52, v53
  v_cvt_pk_bf16_f32 v75, v54, v55
  v_exp_f32 v56, v56
  v_exp_f32 v57, v57
  v_mfma_f32_32x32x16_bf16 v[80:95], v[132:135], v[72:75], v[80:95]
  v_exp_f32 v58, v58
  v_exp_f32 v59, v59
  v_exp_f32 v60, v60
  v_exp_f32 v61, v61
  v_exp_f32 v62, v62
  v_exp_f32 v63, v63
  v_cvt_pk_bf16_f32 v76, v56, v57
  v_cvt_pk_bf16_f32 v77, v58, v59
  v_cvt_pk_bf16_f32 v78, v60, v61
  v_cvt_pk_bf16_f32 v79, v62, v63
  v_exp_f32 v0, v0
  v_exp_f32 v1, v1
  v_mfma_f32_32x32x16_bf16 v[80:95], v[136:139], v[76:79], v[80:95]
  s_cmp_eq_u32 s26, 0
  s_cbranch_scc0 sequential_preLN__mha_block__moe_arch_mod__prompt_kernel_lc80
  s_mov_b32 exec_lo, 0xf0f00000
  s_mov_b32 exec_hi, 0xf0f0
sequential_preLN__mha_block__moe_arch_mod__prompt_kernel_poll83:
  buffer_load_dwordx2 v[164:165], v160, s[20:23], s9 offen offset:64 sc1
  s_waitcnt vmcnt(0)
  v_max_u32 v164, v164, v165
  v_cmp_eq_u32 vcc, -1, v164
  s_nop 4
  s_cbranch_vccz sequential_preLN__mha_block__moe_arch_mod__prompt_kernel_ok84
  s_sub_u32 s75, s75, 1
  s_cbranch_scc1 sequential_preLN__mha_block__moe_arch_mod__prompt_kernel_end1
  s_branch sequential_preLN__mha_block__moe_arch_mod__prompt_kernel_poll83
sequential_preLN__mha_block__moe_arch_mod__prompt_kernel_ok84:
  s_mov_b64 exec, -1
sequential_preLN__mha_block__moe_arch_mod__prompt_kernel_lc80:
  s_waitcnt lgkmcnt(0)
  s_barrier
  v_exp_f32 v2, v2
  v_exp_f32 v3, v3
  v_exp_f32 v4, v4
  v_exp_f32 v5, v5
  v_mfma_f32_32x32x16_bf16 v[32:47], v[96:99], v[140:143], 0
  ds_read_b128 v[96:99], v147 offset:0
  v_exp_f32 v6, v6
  v_exp_f32 v7, v7
  v_cvt_pk_bf16_f32 v64, v0, v1
  v_cvt_pk_bf16_f32 v65, v2, v3
  v_cvt_pk_bf16_f32 v66, v4, v5
  v_cvt_pk_bf16_f32 v67, v6, v7
  v_exp_f32 v8, v8
  v_mfma_f32_32x32x16_bf16 v[48:63], v[100:103], v[140:143], 0
  ds_read_b128 v[100:103], v147 offset:2560
  v_exp_f32 v9, v9
  v_exp_f32 v10, v10
  v_exp_f32 v11, v11
  v_exp_f32 v12, v12
  s_mov_b64 exec, s[40:41]
  v_mfma_f32_32x32x16_bf16 v[80:95], v[108:111], v[64:67], v[80:95]
  ds_read_b128 v[124:127], v152 offset:56320
  ds_read_b128 v[128:131], v152 offset:56960
  ds_read_b128 v[132:135], v152 offset:58880
  ds_read_b128 v[136:139], v152 offset:59520
  s_mov_b64 exec, -1
  v_exp_f32 v13, v13
  v_exp_f32 v14, v14
  v_exp_f32 v15, v15
  v_cvt_pk_bf16_f32 v68, v8, v9
  v_cvt_pk_bf16_f32 v69, v10, v11
  v_cvt_pk_bf16_f32 v70, v12, v13
  v_cvt_pk_bf16_f32 v71, v14, v15
  v_mfma_f32_32x32x4_2b_bf16 v[32:63], v[104:105], v[144:145], v[32:63]
  ds_read_b64 v[104:105], v150 offset:0
  v_exp_f32 v16, v16
  v_exp_f32 v17, v17
  v_exp_f32 v18, v18
  v_exp_f32 v19, v19
  v_exp_f32 v20, v20
  v_exp_f32 v21, v21
  v_exp_f32 v22, v22
  v_exp_f32 v23, v23
  s_add_u32 m0, s31, 81920
  s_add_u32 s33, s32, 81920
  v_mfma_f32_32x32x16_bf16 v[80:95], v[112:115], v[68:71], v[80:95]
  buffer_load_dwordx4 v158, s[20:23], s33 offen sc1 lds
  v_cvt_pk_bf16_f32 v72, v16, v17
  v_cvt_pk_bf16_f32 v73, v18, v19
  v_cvt_pk_bf16_f32 v74, v20, v21
  v_cvt_pk_bf16_f32 v75, v22, v23
  v_exp_f32 v24, v24
  v_exp_f32 v25, v25
  s_add_u32 m0, s31, 90112
  s_add_u32 s33, s32, 90112
  v_mfma_f32_32x32x16_bf16 v[80:95], v[116:119], v[72:75], v[80:95]
  buffer_load_dwordx4 v158, s[20:23], s33 offen sc1 lds
  v_exp_f32 v26, v26
  v_exp_f32 v27, v27
  v_exp_f32 v28, v28
  v_exp_f32 v29, v29
  v_exp_f32 v30, v30
  v_exp_f32 v31, v31
  v_cvt_pk_bf16_f32 v76, v24, v25
  v_cvt_pk_bf16_f32 v77, v26, v27
  v_cvt_pk_bf16_f32 v78, v28, v29
  v_cvt_pk_bf16_f32 v79, v30, v31
  v_exp_f32 v32, v32
  v_exp_f32 v33, v33
  v_mfma_f32_32x32x16_bf16 v[80:95], v[120:123], v[76:79], v[80:95]
  s_waitcnt lgkmcnt(0)
  v_mov_b32 v240, -1
  v_mov_b32 v241, -1
  v_mov_b32 v242, -1
  v_mov_b32 v243, -1
  v_lshlrev_b32 v244, 4, v159
  s_mul_i32 s34, s2, 13856
  s_add_u32 s34, s34, 13107200
  buffer_store_dwordx4 v[240:243], v244, s[20:23], s34 offen sc1
  v_exp_f32 v34, v34
  v_exp_f32 v35, v35
  v_exp_f32 v36, v36
  v_exp_f32 v37, v37
  v_mfma_f32_32x32x16_bf16 v[0:15], v[96:99], v[140:143], 0
  ds_read_b128 v[96:99], v147 offset:5120
  v_exp_f32 v38, v38
  v_exp_f32 v39, v39
  v_cvt_pk_bf16_f32 v64, v32, v33
  v_cvt_pk_bf16_f32 v65, v34, v35
  v_cvt_pk_bf16_f32 v66, v36, v37
  v_cvt_pk_bf16_f32 v67, v38, v39
  v_exp_f32 v40, v40
  v_mfma_f32_32x32x16_bf16 v[16:31], v[100:103], v[140:143], 0
  ds_read_b128 v[100:103], v147 offset:7680
  v_exp_f32 v41, v41
  v_exp_f32 v42, v42
  v_exp_f32 v43, v43
  v_exp_f32 v44, v44
  s_mov_b64 exec, s[40:41]
  v_mfma_f32_32x32x16_bf16 v[80:95], v[124:127], v[64:67], v[80:95]
  ds_read_b128 v[108:111], v153 offset:0
  ds_read_b128 v[112:115], v153 offset:640
  ds_read_b128 v[116:119], v153 offset:2560
  ds_read_b128 v[120:123], v153 offset:3200
  s_mov_b64 exec, -1
  v_exp_f32 v45, v45
  v_exp_f32 v46, v46
  v_exp_f32 v47, v47
  v_cvt_pk_bf16_f32 v68, v40, v41
  v_cvt_pk_bf16_f32 v69, v42, v43
  v_cvt_pk_bf16_f32 v70, v44, v45
  v_cvt_pk_bf16_f32 v71, v46, v47
  v_mfma_f32_32x32x4_2b_bf16 v[0:31], v[104:105], v[144:145], v[0:31]
  ds_read_b64 v[104:105], v150 offset:5120
  v_exp_f32 v48, v48
  v_exp_f32 v49, v49
  v_exp_f32 v50, v50
  v_exp_f32 v51, v51
  v_exp_f32 v52, v52
  v_exp_f32 v53, v53
  v_exp_f32 v54, v54
  v_exp_f32 v55, v55
  s_add_u32 m0, s31, 98304
  s_add_u32 s33, s32, 98304
  v_mfma_f32_32x32x16_bf16 v[80:95], v[128:131], v[68:71], v[80:95]
  buffer_load_dwordx4 v158, s[20:23], s33 offen sc1 lds
  v_cvt_pk_bf16_f32 v72, v48, v49
  v_cvt_pk_bf16_f32 v73, v50, v51
  v_cvt_pk_bf16_f32 v74, v52, v53
  v_cvt_pk_bf16_f32 v75, v54, v55
  v_exp_f32 v56, v56
  v_exp_f32 v57, v57
  s_add_u32 m0, s31, 106496
  s_add_u32 s33, s32, 106496
  v_mfma_f32_32x32x16_bf16 v[80:95], v[132:135], v[72:75], v[80:95]
  buffer_load_dwordx4 v158, s[20:23], s33 offen sc1 lds
  v_exp_f32 v58, v58
  v_exp_f32 v59, v59
  v_exp_f32 v60, v60
  v_exp_f32 v61, v61
  v_exp_f32 v62, v62
  v_exp_f32 v63, v63
  v_cvt_pk_bf16_f32 v76, v56, v57
  v_cvt_pk_bf16_f32 v77, v58, v59
  v_cvt_pk_bf16_f32 v78, v60, v61
  v_cvt_pk_bf16_f32 v79, v62, v63
  v_exp_f32 v0, v0
  v_exp_f32 v1, v1
  v_mfma_f32_32x32x16_bf16 v[80:95], v[136:139], v[76:79], v[80:95]
  s_waitcnt lgkmcnt(0)
  s_cmp_ge_u32 s26, 6
  s_cselect_b32 s22, 0, s22
  s_add_u32 s34, s34, 8192
  buffer_store_dwordx4 v[240:243], v244, s[20:23], s34 offen sc1
  s_mov_b32 s22, 268435456
  v_exp_f32 v2, v2
  v_exp_f32 v3, v3
  v_exp_f32 v4, v4
  v_exp_f32 v5, v5
  v_mfma_f32_32x32x16_bf16 v[32:47], v[96:99], v[140:143], 0
  ds_read_b128 v[96:99], v147 offset:10240
  v_exp_f32 v6, v6
  v_exp_f32 v7, v7
  v_cvt_pk_bf16_f32 v64, v0, v1
  v_cvt_pk_bf16_f32 v65, v2, v3
  v_cvt_pk_bf16_f32 v66, v4, v5
  v_cvt_pk_bf16_f32 v67, v6, v7
  v_exp_f32 v8, v8
  v_mfma_f32_32x32x16_bf16 v[48:63], v[100:103], v[140:143], 0
  ds_read_b128 v[100:103], v147 offset:12800
  v_exp_f32 v9, v9
  v_exp_f32 v10, v10
  v_exp_f32 v11, v11
  v_exp_f32 v12, v12
  s_mov_b64 exec, s[40:41]
  v_mfma_f32_32x32x16_bf16 v[80:95], v[108:111], v[64:67], v[80:95]
  ds_read_b128 v[124:127], v153 offset:5120
  ds_read_b128 v[128:131], v153 offset:5760
  ds_read_b128 v[132:135], v153 offset:7680
  ds_read_b128 v[136:139], v153 offset:8320
  s_mov_b64 exec, -1
  v_exp_f32 v13, v13
  v_exp_f32 v14, v14
  v_exp_f32 v15, v15
  v_cvt_pk_bf16_f32 v68, v8, v9
  v_cvt_pk_bf16_f32 v69, v10, v11
  v_cvt_pk_bf16_f32 v70, v12, v13
  v_cvt_pk_bf16_f32 v71, v14, v15
  v_mfma_f32_32x32x4_2b_bf16 v[32:63], v[104:105], v[144:145], v[32:63]
  ds_read_b64 v[104:105], v150 offset:10240
  v_exp_f32 v16, v16
  v_exp_f32 v17, v17
  v_exp_f32 v18, v18
  v_exp_f32 v19, v19
  v_exp_f32 v20, v20
  v_exp_f32 v21, v21
  v_exp_f32 v22, v22
  v_exp_f32 v23, v23
  s_add_u32 m0, s31, 114688
  s_add_u32 s33, s32, 114688
  v_mfma_f32_32x32x16_bf16 v[80:95], v[112:115], v[68:71], v[80:95]
  buffer_load_dwordx4 v158, s[20:23], s33 offen sc1 lds
  v_cvt_pk_bf16_f32 v72, v16, v17
  v_cvt_pk_bf16_f32 v73, v18, v19
  v_cvt_pk_bf16_f32 v74, v20, v21
  v_cvt_pk_bf16_f32 v75, v22, v23
  v_exp_f32 v24, v24
  v_exp_f32 v25, v25
  s_add_u32 m0, s31, 122880
  s_add_u32 s33, s32, 122880
  v_mfma_f32_32x32x16_bf16 v[80:95], v[116:119], v[72:75], v[80:95]
  buffer_load_dwordx4 v158, s[20:23], s33 offen sc1 lds
  v_exp_f32 v26, v26
  v_exp_f32 v27, v27
  v_exp_f32 v28, v28
  v_exp_f32 v29, v29
  v_exp_f32 v30, v30
  v_exp_f32 v31, v31
  v_cvt_pk_bf16_f32 v76, v24, v25
  v_cvt_pk_bf16_f32 v77, v26, v27
  v_cvt_pk_bf16_f32 v78, v28, v29
  v_cvt_pk_bf16_f32 v79, v30, v31
  v_exp_f32 v32, v32
  v_exp_f32 v33, v33
  v_mfma_f32_32x32x16_bf16 v[80:95], v[120:123], v[76:79], v[80:95]
  s_waitcnt lgkmcnt(0)
  v_exp_f32 v34, v34
  v_exp_f32 v35, v35
  v_exp_f32 v36, v36
  v_exp_f32 v37, v37
  v_mfma_f32_32x32x16_bf16 v[0:15], v[96:99], v[140:143], 0
  ds_read_b128 v[96:99], v147 offset:15360
  v_exp_f32 v38, v38
  v_exp_f32 v39, v39
  v_cvt_pk_bf16_f32 v64, v32, v33
  v_cvt_pk_bf16_f32 v65, v34, v35
  v_cvt_pk_bf16_f32 v66, v36, v37
  v_cvt_pk_bf16_f32 v67, v38, v39
  v_exp_f32 v40, v40
  v_mfma_f32_32x32x16_bf16 v[16:31], v[100:103], v[140:143], 0
  ds_read_b128 v[100:103], v147 offset:17920
  v_exp_f32 v41, v41
  v_exp_f32 v42, v42
  v_exp_f32 v43, v43
  v_exp_f32 v44, v44
  s_mov_b64 exec, s[40:41]
  v_mfma_f32_32x32x16_bf16 v[80:95], v[124:127], v[64:67], v[80:95]
  ds_read_b128 v[108:111], v153 offset:10240
  ds_read_b128 v[112:115], v153 offset:10880
  ds_read_b128 v[116:119], v153 offset:12800
  ds_read_b128 v[120:123], v153 offset:13440
  s_mov_b64 exec, -1
  v_exp_f32 v45, v45
  v_exp_f32 v46, v46
  v_exp_f32 v47, v47
  v_cvt_pk_bf16_f32 v68, v40, v41
  v_cvt_pk_bf16_f32 v69, v42, v43
  v_cvt_pk_bf16_f32 v70, v44, v45
  v_cvt_pk_bf16_f32 v71, v46, v47
  v_mfma_f32_32x32x4_2b_bf16 v[0:31], v[104:105], v[144:145], v[0:31]
  ds_read_b64 v[104:105], v150 offset:15360
  v_exp_f32 v48, v48
  v_exp_f32 v49, v49
  v_exp_f32 v50, v50
  v_exp_f32 v51, v51
  v_exp_f32 v52, v52
  v_exp_f32 v53, v53
  v_exp_f32 v54, v54
  v_exp_f32 v55, v55
  s_add_u32 m0, s31, 131072
  s_add_u32 s33, s32, 131072
  v_mfma_f32_32x32x16_bf16 v[80:95], v[128:131], v[68:71], v[80:95]
  buffer_load_dwordx4 v158, s[20:23], s33 offen sc1 lds
  v_cvt_pk_bf16_f32 v72, v48, v49
  v_cvt_pk_bf16_f32 v73, v50, v51
  v_cvt_pk_bf16_f32 v74, v52, v53
  v_cvt_pk_bf16_f32 v75, v54, v55
  v_exp_f32 v56, v56
  v_exp_f32 v57, v57
  s_add_u32 m0, s31, 139264
  s_add_u32 s33, s32, 139264
  v_mfma_f32_32x32x16_bf16 v[80:95], v[132:135], v[72:75], v[80:95]
  buffer_load_dwordx4 v158, s[20:23], s33 offen sc1 lds
  v_exp_f32 v58, v58
  v_exp_f32 v59, v59
  v_exp_f32 v60, v60
  v_exp_f32 v61, v61
  v_exp_f32 v62, v62
  v_exp_f32 v63, v63
  v_cvt_pk_bf16_f32 v76, v56, v57
  v_cvt_pk_bf16_f32 v77, v58, v59
  v_cvt_pk_bf16_f32 v78, v60, v61
  v_cvt_pk_bf16_f32 v79, v62, v63
  v_exp_f32 v0, v0
  v_exp_f32 v1, v1
  v_mfma_f32_32x32x16_bf16 v[80:95], v[136:139], v[76:79], v[80:95]
  s_waitcnt vmcnt(5) lgkmcnt(0)
  s_barrier
  v_exp_f32 v2, v2
  v_exp_f32 v3, v3
  v_exp_f32 v4, v4
  v_exp_f32 v5, v5
  v_mfma_f32_32x32x16_bf16 v[32:47], v[96:99], v[140:143], 0
  ds_read_b128 v[96:99], v147 offset:20480
  v_exp_f32 v6, v6
  v_exp_f32 v7, v7
  v_cvt_pk_bf16_f32 v64, v0, v1
  v_cvt_pk_bf16_f32 v65, v2, v3
  v_cvt_pk_bf16_f32 v66, v4, v5
  v_cvt_pk_bf16_f32 v67, v6, v7
  v_exp_f32 v8, v8
  v_mfma_f32_32x32x16_bf16 v[48:63], v[100:103], v[140:143], 0
  ds_read_b128 v[100:103], v147 offset:23040
  v_exp_f32 v9, v9
  v_exp_f32 v10, v10
  v_exp_f32 v11, v11
  v_exp_f32 v12, v12
  s_mov_b64 exec, s[40:41]
  v_mfma_f32_32x32x16_bf16 v[80:95], v[108:111], v[64:67], v[80:95]
  ds_read_b128 v[124:127], v153 offset:15360
  ds_read_b128 v[128:131], v153 offset:16000
  ds_read_b128 v[132:135], v153 offset:17920
  ds_read_b128 v[136:139], v153 offset:18560
  s_mov_b64 exec, -1
  v_exp_f32 v13, v13
  v_exp_f32 v14, v14
  v_exp_f32 v15, v15
  v_cvt_pk_bf16_f32 v68, v8, v9
  v_cvt_pk_bf16_f32 v69, v10, v11
  v_cvt_pk_bf16_f32 v70, v12, v13
  v_cvt_pk_bf16_f32 v71, v14, v15
  v_mfma_f32_32x32x4_2b_bf16 v[32:63], v[104:105], v[144:145], v[32:63]
  ds_read_b64 v[104:105], v150 offset:20480
  v_exp_f32 v16, v16
  v_exp_f32 v17, v17
  v_exp_f32 v18, v18
  v_exp_f32 v19, v19
  v_exp_f32 v20, v20
  v_exp_f32 v21, v21
  v_exp_f32 v22, v22
  v_exp_f32 v23, v23
  s_add_u32 m0, s31, 147456
  s_add_u32 s33, s32, 147456
  v_mfma_f32_32x32x16_bf16 v[80:95], v[112:115], v[68:71], v[80:95]
  buffer_load_dwordx4 v158, s[20:23], s33 offen sc1 lds
  v_cvt_pk_bf16_f32 v72, v16, v17
  v_cvt_pk_bf16_f32 v73, v18, v19
  v_cvt_pk_bf16_f32 v74, v20, v21
  v_cvt_pk_bf16_f32 v75, v22, v23
  v_exp_f32 v24, v24
  v_exp_f32 v25, v25
  s_add_u32 m0, s31, 155648
  s_add_u32 s33, s32, 155648
  v_mfma_f32_32x32x16_bf16 v[80:95], v[116:119], v[72:75], v[80:95]
  buffer_load_dwordx4 v158, s[20:23], s33 offen sc1 lds
  v_exp_f32 v26, v26
  v_exp_f32 v27, v27
  v_exp_f32 v28, v28
  v_exp_f32 v29, v29
  v_exp_f32 v30, v30
  v_exp_f32 v31, v31
  v_cvt_pk_bf16_f32 v76, v24, v25
  v_cvt_pk_bf16_f32 v77, v26, v27
  v_cvt_pk_bf16_f32 v78, v28, v29
  v_cvt_pk_bf16_f32 v79, v30, v31
  v_exp_f32 v32, v32
  v_exp_f32 v33, v33
  v_mfma_f32_32x32x16_bf16 v[80:95], v[120:123], v[76:79], v[80:95]
  s_waitcnt lgkmcnt(0)
  v_exp_f32 v34, v34
  v_exp_f32 v35, v35
  v_exp_f32 v36, v36
  v_exp_f32 v37, v37
  v_mfma_f32_32x32x16_bf16 v[0:15], v[96:99], v[140:143], 0
  ds_read_b128 v[96:99], v147 offset:25600
  v_exp_f32 v38, v38
  v_exp_f32 v39, v39
  v_cvt_pk_bf16_f32 v64, v32, v33
  v_cvt_pk_bf16_f32 v65, v34, v35
  v_cvt_pk_bf16_f32 v66, v36, v37
  v_cvt_pk_bf16_f32 v67, v38, v39
  v_exp_f32 v40, v40
  v_mfma_f32_32x32x16_bf16 v[16:31], v[100:103], v[140:143], 0
  ds_read_b128 v[100:103], v147 offset:28160
  v_exp_f32 v41, v41
  v_exp_f32 v42, v42
  v_exp_f32 v43, v43
  v_exp_f32 v44, v44
  s_mov_b64 exec, s[40:41]
  v_mfma_f32_32x32x16_bf16 v[80:95], v[124:127], v[64:67], v[80:95]
  ds_read_b128 v[108:111], v153 offset:20480
  ds_read_b128 v[112:115], v153 offset:21120
  ds_read_b128 v[116:119], v153 offset:23040
  ds_read_b128 v[120:123], v153 offset:23680
  s_mov_b64 exec, -1
  v_exp_f32 v45, v45
  v_exp_f32 v46, v46
  v_exp_f32 v47, v47
  v_cvt_pk_bf16_f32 v68, v40, v41
  v_cvt_pk_bf16_f32 v69, v42, v43
  v_cvt_pk_bf16_f32 v70, v44, v45
  v_cvt_pk_bf16_f32 v71, v46, v47
  v_mfma_f32_32x32x4_2b_bf16 v[0:31], v[104:105], v[144:145], v[0:31]
  ds_read_b64 v[104:105], v150 offset:25600
  v_exp_f32 v48, v48
  v_exp_f32 v49, v49
  v_exp_f32 v50, v50
  v_exp_f32 v51, v51
  v_exp_f32 v52, v52
  v_exp_f32 v53, v53
  v_exp_f32 v54, v54
  v_exp_f32 v55, v55
  v_mfma_f32_32x32x16_bf16 v[80:95], v[128:131], v[68:71], v[80:95]
  buffer_load_dword v206, v174, s[4:7], s52 offen offset:0
  v_cvt_pk_bf16_f32 v72, v48, v49
  v_cvt_pk_bf16_f32 v73, v50, v51
  v_cvt_pk_bf16_f32 v74, v52, v53
  v_cvt_pk_bf16_f32 v75, v54, v55
  v_exp_f32 v56, v56
  v_exp_f32 v57, v57
  v_mfma_f32_32x32x16_bf16 v[80:95], v[132:135], v[72:75], v[80:95]
  buffer_load_dword v207, v174, s[4:7], s52 offen offset:1280
  v_exp_f32 v58, v58
  v_exp_f32 v59, v59
  v_exp_f32 v60, v60
  v_exp_f32 v61, v61
  v_exp_f32 v62, v62
  v_exp_f32 v63, v63
  v_cvt_pk_bf16_f32 v76, v56, v57
  v_cvt_pk_bf16_f32 v77, v58, v59
  v_cvt_pk_bf16_f32 v78, v60, v61
  v_cvt_pk_bf16_f32 v79, v62, v63
  v_exp_f32 v0, v0
  v_exp_f32 v1, v1
  v_mfma_f32_32x32x16_bf16 v[80:95], v[136:139], v[76:79], v[80:95]
  s_waitcnt lgkmcnt(0)
  v_exp_f32 v2, v2
  v_exp_f32 v3, v3
  v_exp_f32 v4, v4
  v_exp_f32 v5, v5
  v_mfma_f32_32x32x16_bf16 v[32:47], v[96:99], v[140:143], 0
  ds_read_b128 v[96:99], v147 offset:30720
  v_exp_f32 v6, v6
  v_exp_f32 v7, v7
  v_cvt_pk_bf16_f32 v64, v0, v1
  v_cvt_pk_bf16_f32 v65, v2, v3
  v_cvt_pk_bf16_f32 v66, v4, v5
  v_cvt_pk_bf16_f32 v67, v6, v7
  v_exp_f32 v8, v8
  v_mfma_f32_32x32x16_bf16 v[48:63], v[100:103], v[140:143], 0
  ds_read_b128 v[100:103], v147 offset:33280
  v_exp_f32 v9, v9
  v_exp_f32 v10, v10
  v_exp_f32 v11, v11
  v_exp_f32 v12, v12
  s_mov_b64 exec, s[40:41]
  v_mfma_f32_32x32x16_bf16 v[80:95], v[108:111], v[64:67], v[80:95]
  ds_read_b128 v[124:127], v153 offset:25600
  ds_read_b128 v[128:131], v153 offset:26240
  ds_read_b128 v[132:135], v153 offset:28160
  ds_read_b128 v[136:139], v153 offset:28800
  s_mov_b64 exec, -1
  v_exp_f32 v13, v13
  v_exp_f32 v14, v14
  v_exp_f32 v15, v15
  v_cvt_pk_bf16_f32 v68, v8, v9
  v_cvt_pk_bf16_f32 v69, v10, v11
  v_cvt_pk_bf16_f32 v70, v12, v13
  v_cvt_pk_bf16_f32 v71, v14, v15
  v_mfma_f32_32x32x4_2b_bf16 v[32:63], v[104:105], v[144:145], v[32:63]
  ds_read_b64 v[104:105], v150 offset:30720
  v_exp_f32 v16, v16
  v_exp_f32 v17, v17
  v_exp_f32 v18, v18
  v_exp_f32 v19, v19
  v_exp_f32 v20, v20
  v_exp_f32 v21, v21
  v_exp_f32 v22, v22
  v_exp_f32 v23, v23
  v_mfma_f32_32x32x16_bf16 v[80:95], v[112:115], v[68:71], v[80:95]
  buffer_load_dword v208, v174, s[4:7], s52 offen offset:2560
  v_cvt_pk_bf16_f32 v72, v16, v17
  v_cvt_pk_bf16_f32 v73, v18, v19
  v_cvt_pk_bf16_f32 v74, v20, v21
  v_cvt_pk_bf16_f32 v75, v22, v23
  v_exp_f32 v24, v24
  v_exp_f32 v25, v25
  v_mfma_f32_32x32x16_bf16 v[80:95], v[116:119], v[72:75], v[80:95]
  buffer_load_dword v209, v174, s[4:7], s52 offen offset:3840
  v_exp_f32 v26, v26
  v_exp_f32 v27, v27
  v_exp_f32 v28, v28
  v_exp_f32 v29, v29
  v_exp_f32 v30, v30
  v_exp_f32 v31, v31
  v_cvt_pk_bf16_f32 v76, v24, v25
  v_cvt_pk_bf16_f32 v77, v26, v27
  v_cvt_pk_bf16_f32 v78, v28, v29
  v_cvt_pk_bf16_f32 v79, v30, v31
  v_exp_f32 v32, v32
  v_exp_f32 v33, v33
  v_mfma_f32_32x32x16_bf16 v[80:95], v[120:123], v[76:79], v[80:95]
  s_waitcnt lgkmcnt(0)
  v_exp_f32 v34, v34
  v_exp_f32 v35, v35
  v_exp_f32 v36, v36
  v_exp_f32 v37, v37
  v_mfma_f32_32x32x16_bf16 v[0:15], v[96:99], v[140:143], 0
  ds_read_b128 v[96:99], v147 offset:35840
  v_exp_f32 v38, v38
  v_exp_f32 v39, v39
  v_cvt_pk_bf16_f32 v64, v32, v33
  v_cvt_pk_bf16_f32 v65, v34, v35
  v_cvt_pk_bf16_f32 v66, v36, v37
  v_cvt_pk_bf16_f32 v67, v38, v39
  v_exp_f32 v40, v40
  v_mfma_f32_32x32x16_bf16 v[16:31], v[100:103], v[140:143], 0
  ds_read_b128 v[100:103], v147 offset:38400
  v_exp_f32 v41, v41
  v_exp_f32 v42, v42
  v_exp_f32 v43, v43
  v_exp_f32 v44, v44
  s_mov_b64 exec, s[40:41]
  v_mfma_f32_32x32x16_bf16 v[80:95], v[124:127], v[64:67], v[80:95]
  ds_read_b128 v[108:111], v153 offset:30720
  ds_read_b128 v[112:115], v153 offset:31360
  ds_read_b128 v[116:119], v153 offset:33280
  ds_read_b128 v[120:123], v153 offset:33920
  s_mov_b64 exec, -1
  v_exp_f32 v45, v45
  v_exp_f32 v46, v46
  v_exp_f32 v47, v47
  v_cvt_pk_bf16_f32 v68, v40, v41
  v_cvt_pk_bf16_f32 v69, v42, v43
  v_cvt_pk_bf16_f32 v70, v44, v45
  v_cvt_pk_bf16_f32 v71, v46, v47
  v_mfma_f32_32x32x4_2b_bf16 v[0:31], v[104:105], v[144:145], v[0:31]
  ds_read_b64 v[104:105], v150 offset:35840
  v_exp_f32 v48, v48
  v_exp_f32 v49, v49
  v_exp_f32 v50, v50
  v_exp_f32 v51, v51
  v_exp_f32 v52, v52
  v_exp_f32 v53, v53
  v_exp_f32 v54, v54
  v_exp_f32 v55, v55
  v_mfma_f32_32x32x16_bf16 v[80:95], v[128:131], v[68:71], v[80:95]
  buffer_load_dword v210, v174, s[4:7], s53 offen offset:0
  v_cvt_pk_bf16_f32 v72, v48, v49
  v_cvt_pk_bf16_f32 v73, v50, v51
  v_cvt_pk_bf16_f32 v74, v52, v53
  v_cvt_pk_bf16_f32 v75, v54, v55
  v_exp_f32 v56, v56
  v_exp_f32 v57, v57
  v_mfma_f32_32x32x16_bf16 v[80:95], v[132:135], v[72:75], v[80:95]
  buffer_load_dword v211, v174, s[4:7], s53 offen offset:1280
  v_exp_f32 v58, v58
  v_exp_f32 v59, v59
  v_exp_f32 v60, v60
  v_exp_f32 v61, v61
  v_exp_f32 v62, v62
  v_exp_f32 v63, v63
  v_cvt_pk_bf16_f32 v76, v56, v57
  v_cvt_pk_bf16_f32 v77, v58, v59
  v_cvt_pk_bf16_f32 v78, v60, v61
  v_cvt_pk_bf16_f32 v79, v62, v63
  v_exp_f32 v0, v0
  v_exp_f32 v1, v1
  v_mfma_f32_32x32x16_bf16 v[80:95], v[136:139], v[76:79], v[80:95]
  s_waitcnt lgkmcnt(0)
  v_exp_f32 v2, v2
  v_exp_f32 v3, v3
  v_exp_f32 v4, v4
  v_exp_f32 v5, v5
  v_mfma_f32_32x32x16_bf16 v[32:47], v[96:99], v[140:143], 0
  ds_read_b128 v[96:99], v147 offset:40960
  v_exp_f32 v6, v6
  v_exp_f32 v7, v7
  v_cvt_pk_bf16_f32 v64, v0, v1
  v_cvt_pk_bf16_f32 v65, v2, v3
  v_cvt_pk_bf16_f32 v66, v4, v5
  v_cvt_pk_bf16_f32 v67, v6, v7
  v_exp_f32 v8, v8
  v_mfma_f32_32x32x16_bf16 v[48:63], v[100:103], v[140:143], 0
  ds_read_b128 v[100:103], v147 offset:43520
  v_exp_f32 v9, v9
  v_exp_f32 v10, v10
  v_exp_f32 v11, v11
  v_exp_f32 v12, v12
  s_mov_b64 exec, s[40:41]
  v_mfma_f32_32x32x16_bf16 v[80:95], v[108:111], v[64:67], v[80:95]
  ds_read_b128 v[124:127], v153 offset:35840
  ds_read_b128 v[128:131], v153 offset:36480
  ds_read_b128 v[132:135], v153 offset:38400
  ds_read_b128 v[136:139], v153 offset:39040
  s_mov_b64 exec, -1
  v_exp_f32 v13, v13
  v_exp_f32 v14, v14
  v_exp_f32 v15, v15
  v_cvt_pk_bf16_f32 v68, v8, v9
  v_cvt_pk_bf16_f32 v69, v10, v11
  v_cvt_pk_bf16_f32 v70, v12, v13
  v_cvt_pk_bf16_f32 v71, v14, v15
  v_mfma_f32_32x32x4_2b_bf16 v[32:63], v[104:105], v[144:145], v[32:63]
  ds_read_b64 v[104:105], v150 offset:40960
  v_exp_f32 v16, v16
  v_exp_f32 v17, v17
  v_exp_f32 v18, v18
  v_exp_f32 v19, v19
  v_exp_f32 v20, v20
  v_exp_f32 v21, v21
  v_exp_f32 v22, v22
  v_exp_f32 v23, v23
  v_mfma_f32_32x32x16_bf16 v[80:95], v[112:115], v[68:71], v[80:95]
  buffer_load_dword v212, v174, s[4:7], s53 offen offset:2560
  v_cvt_pk_bf16_f32 v72, v16, v17
  v_cvt_pk_bf16_f32 v73, v18, v19
  v_cvt_pk_bf16_f32 v74, v20, v21
  v_cvt_pk_bf16_f32 v75, v22, v23
  v_exp_f32 v24, v24
  v_exp_f32 v25, v25
  v_mfma_f32_32x32x16_bf16 v[80:95], v[116:119], v[72:75], v[80:95]
  buffer_load_dword v213, v174, s[4:7], s53 offen offset:3840
  v_exp_f32 v26, v26
  v_exp_f32 v27, v27
  v_exp_f32 v28, v28
  v_exp_f32 v29, v29
  v_exp_f32 v30, v30
  v_exp_f32 v31, v31
  v_cvt_pk_bf16_f32 v76, v24, v25
  v_cvt_pk_bf16_f32 v77, v26, v27
  v_cvt_pk_bf16_f32 v78, v28, v29
  v_cvt_pk_bf16_f32 v79, v30, v31
  v_exp_f32 v32, v32
  v_exp_f32 v33, v33
  v_mfma_f32_32x32x16_bf16 v[80:95], v[120:123], v[76:79], v[80:95]
  s_waitcnt lgkmcnt(0)
  v_exp_f32 v34, v34
  v_exp_f32 v35, v35
  v_exp_f32 v36, v36
  v_exp_f32 v37, v37
  v_mfma_f32_32x32x16_bf16 v[0:15], v[96:99], v[140:143], 0
  ds_read_b128 v[96:99], v147 offset:46080
  v_exp_f32 v38, v38
  v_exp_f32 v39, v39
  v_cvt_pk_bf16_f32 v64, v32, v33
  v_cvt_pk_bf16_f32 v65, v34, v35
  v_cvt_pk_bf16_f32 v66, v36, v37
  v_cvt_pk_bf16_f32 v67, v38, v39
  v_exp_f32 v40, v40
  v_mfma_f32_32x32x16_bf16 v[16:31], v[100:103], v[140:143], 0
  ds_read_b128 v[100:103], v147 offset:48640
  v_exp_f32 v41, v41
  v_exp_f32 v42, v42
  v_exp_f32 v43, v43
  v_exp_f32 v44, v44
  s_mov_b64 exec, s[40:41]
  v_mfma_f32_32x32x16_bf16 v[80:95], v[124:127], v[64:67], v[80:95]
  ds_read_b128 v[108:111], v153 offset:40960
  ds_read_b128 v[112:115], v153 offset:41600
  ds_read_b128 v[116:119], v153 offset:43520
  ds_read_b128 v[120:123], v153 offset:44160
  s_mov_b64 exec, -1
  v_exp_f32 v45, v45
  v_exp_f32 v46, v46
  v_exp_f32 v47, v47
  v_cvt_pk_bf16_f32 v68, v40, v41
  v_cvt_pk_bf16_f32 v69, v42, v43
  v_cvt_pk_bf16_f32 v70, v44, v45
  v_cvt_pk_bf16_f32 v71, v46, v47
  v_mfma_f32_32x32x4_2b_bf16 v[0:31], v[104:105], v[144:145], v[0:31]
  ds_read_b64 v[104:105], v150 offset:46080
  v_exp_f32 v48, v48
  v_exp_f32 v49, v49
  v_exp_f32 v50, v50
  v_exp_f32 v51, v51
  v_exp_f32 v52, v52
  v_exp_f32 v53, v53
  v_exp_f32 v54, v54
  v_exp_f32 v55, v55
  v_mfma_f32_32x32x16_bf16 v[80:95], v[128:131], v[68:71], v[80:95]
  buffer_load_dwordx4 v[190:193], v173, s[16:19], s74 offen offset:0
  v_cvt_pk_bf16_f32 v72, v48, v49
  v_cvt_pk_bf16_f32 v73, v50, v51
  v_cvt_pk_bf16_f32 v74, v52, v53
  v_cvt_pk_bf16_f32 v75, v54, v55
  v_exp_f32 v56, v56
  v_exp_f32 v57, v57
  v_mfma_f32_32x32x16_bf16 v[80:95], v[132:135], v[72:75], v[80:95]
  buffer_load_dwordx4 v[194:197], v173, s[16:19], s74 offen offset:3456
  v_exp_f32 v58, v58
  v_exp_f32 v59, v59
  v_exp_f32 v60, v60
  v_exp_f32 v61, v61
  v_exp_f32 v62, v62
  v_exp_f32 v63, v63
  v_cvt_pk_bf16_f32 v76, v56, v57
  v_cvt_pk_bf16_f32 v77, v58, v59
  v_cvt_pk_bf16_f32 v78, v60, v61
  v_cvt_pk_bf16_f32 v79, v62, v63
  s_setprio 3
  v_exp_f32 v0, v0
  v_exp_f32 v1, v1
  v_mfma_f32_32x32x16_bf16 v[80:95], v[136:139], v[76:79], v[80:95]
  s_waitcnt vmcnt(10) lgkmcnt(0)
  s_barrier
  s_cmp_eq_u32 s26, 2
  s_cbranch_scc0 sequential_preLN__mha_block__moe_arch_mod__prompt_kernel_f385
  v_subrev_u32 v240, 32, v177
  s_mov_b64 exec, 0x1ff
  buffer_store_dword v240, v176, s[20:23], s8 offen sc1
  s_mov_b64 exec, -1
sequential_preLN__mha_block__moe_arch_mod__prompt_kernel_f385:
  v_exp_f32 v2, v2
  v_exp_f32 v3, v3
  v_exp_f32 v4, v4
  v_exp_f32 v5, v5
  v_mfma_f32_32x32x16_bf16 v[32:47], v[96:99], v[140:143], 0
  ds_read_b128 v[96:99], v147 offset:51200
  v_exp_f32 v6, v6
  v_exp_f32 v7, v7
  v_cvt_pk_bf16_f32 v64, v0, v1
  v_cvt_pk_bf16_f32 v65, v2, v3
  v_cvt_pk_bf16_f32 v66, v4, v5
  v_cvt_pk_bf16_f32 v67, v6, v7
  v_exp_f32 v8, v8
  v_mfma_f32_32x32x16_bf16 v[48:63], v[100:103], v[140:143], 0
  ds_read_b128 v[100:103], v147 offset:53760
  v_exp_f32 v9, v9
  v_exp_f32 v10, v10
  v_exp_f32 v11, v11
  v_exp_f32 v12, v12
  s_mov_b64 exec, s[40:41]
  v_mfma_f32_32x32x16_bf16 v[80:95], v[108:111], v[64:67], v[80:95]
  ds_read_b128 v[124:127], v153 offset:46080
  ds_read_b128 v[128:131], v153 offset:46720
  ds_read_b128 v[132:135], v153 offset:48640
  ds_read_b128 v[136:139], v153 offset:49280
  s_mov_b64 exec, -1
  v_exp_f32 v13, v13
  v_exp_f32 v14, v14
  v_exp_f32 v15, v15
  v_cvt_pk_bf16_f32 v68, v8, v9
  v_cvt_pk_bf16_f32 v69, v10, v11
  v_cvt_pk_bf16_f32 v70, v12, v13
  v_cvt_pk_bf16_f32 v71, v14, v15
  v_mfma_f32_32x32x4_2b_bf16 v[32:63], v[104:105], v[144:145], v[32:63]
  ds_read_b64 v[104:105], v150 offset:51200
  v_exp_f32 v16, v16
  v_exp_f32 v17, v17
  v_exp_f32 v18, v18
  v_exp_f32 v19, v19
  v_exp_f32 v20, v20
  v_exp_f32 v21, v21
  v_exp_f32 v22, v22
  v_exp_f32 v23, v23
  s_add_u32 m0, s73, 0
  v_mfma_f32_32x32x16_bf16 v[80:95], v[112:115], v[68:71], v[80:95]
  buffer_load_dwordx4 v168, s[12:15], s70 offen lds
  v_cvt_pk_bf16_f32 v72, v16, v17
  v_cvt_pk_bf16_f32 v73, v18, v19
  v_cvt_pk_bf16_f32 v74, v20, v21
  v_cvt_pk_bf16_f32 v75, v22, v23
  v_exp_f32 v24, v24
  v_exp_f32 v25, v25
  s_add_u32 m0, s73, 1024
  v_mfma_f32_32x32x16_bf16 v[80:95], v[116:119], v[72:75], v[80:95]
  buffer_load_dwordx4 v169, s[12:15], s70 offen lds
  v_exp_f32 v26, v26
  v_exp_f32 v27, v27
  v_exp_f32 v28, v28
  v_exp_f32 v29, v29
  v_exp_f32 v30, v30
  v_exp_f32 v31, v31
  v_cvt_pk_bf16_f32 v76, v24, v25
  v_cvt_pk_bf16_f32 v77, v26, v27
  v_cvt_pk_bf16_f32 v78, v28, v29
  v_cvt_pk_bf16_f32 v79, v30, v31
  s_setprio 2
  v_exp_f32 v32, v32
  v_exp_f32 v33, v33
  v_mfma_f32_32x32x16_bf16 v[80:95], v[120:123], v[76:79], v[80:95]
  s_waitcnt lgkmcnt(0)
  v_exp_f32 v34, v34
  v_exp_f32 v35, v35
  v_exp_f32 v36, v36
  v_exp_f32 v37, v37
  v_mfma_f32_32x32x16_bf16 v[0:15], v[96:99], v[140:143], 0
  ds_read_b128 v[96:99], v147 offset:56320
  v_exp_f32 v38, v38
  v_exp_f32 v39, v39
  v_cvt_pk_bf16_f32 v64, v32, v33
  v_cvt_pk_bf16_f32 v65, v34, v35
  v_cvt_pk_bf16_f32 v66, v36, v37
  v_cvt_pk_bf16_f32 v67, v38, v39
  v_exp_f32 v40, v40
  v_mfma_f32_32x32x16_bf16 v[16:31], v[100:103], v[140:143], 0
  ds_read_b128 v[100:103], v147 offset:58880
  v_exp_f32 v41, v41
  v_exp_f32 v42, v42
  v_exp_f32 v43, v43
  v_exp_f32 v44, v44
  s_mov_b64 exec, s[40:41]
  v_mfma_f32_32x32x16_bf16 v[80:95], v[124:127], v[64:67], v[80:95]
  ds_read_b128 v[108:111], v153 offset:51200
  ds_read_b128 v[112:115], v153 offset:51840
  ds_read_b128 v[116:119], v153 offset:53760
  ds_read_b128 v[120:123], v153 offset:54400
  s_mov_b64 exec, -1
  v_exp_f32 v45, v45
  v_exp_f32 v46, v46
  v_exp_f32 v47, v47
  v_cvt_pk_bf16_f32 v68, v40, v41
  v_cvt_pk_bf16_f32 v69, v42, v43
  v_cvt_pk_bf16_f32 v70, v44, v45
  v_cvt_pk_bf16_f32 v71, v46, v47
  v_mfma_f32_32x32x4_2b_bf16 v[0:31], v[104:105], v[144:145], v[0:31]
  ds_read_b64 v[104:105], v150 offset:56320
  v_exp_f32 v48, v48
  v_exp_f32 v49, v49
  v_exp_f32 v50, v50
  v_exp_f32 v51, v51
  v_exp_f32 v52, v52
  v_exp_f32 v53, v53
  v_exp_f32 v54, v54
  v_exp_f32 v55, v55
  s_add_u32 m0, s73, 2048
  v_mfma_f32_32x32x16_bf16 v[80:95], v[128:131], v[68:71], v[80:95]
  buffer_load_dwordx4 v170, s[12:15], s70 offen lds
  v_cvt_pk_bf16_f32 v72, v48, v49
  v_cvt_pk_bf16_f32 v73, v50, v51
  v_cvt_pk_bf16_f32 v74, v52, v53
  v_cvt_pk_bf16_f32 v75, v54, v55
  v_exp_f32 v56, v56
  v_exp_f32 v57, v57
  s_add_u32 m0, s73, 3072
  v_mfma_f32_32x32x16_bf16 v[80:95], v[132:135], v[72:75], v[80:95]
  buffer_load_dwordx4 v171, s[12:15], s70 offen lds
  v_exp_f32 v58, v58
  v_exp_f32 v59, v59
  v_exp_f32 v60, v60
  v_exp_f32 v61, v61
  v_exp_f32 v62, v62
  v_exp_f32 v63, v63
  v_cvt_pk_bf16_f32 v76, v56, v57
  v_cvt_pk_bf16_f32 v77, v58, v59
  v_cvt_pk_bf16_f32 v78, v60, v61
  v_cvt_pk_bf16_f32 v79, v62, v63
  s_setprio 1
  v_exp_f32 v0, v0
  v_exp_f32 v1, v1
  v_mfma_f32_32x32x16_bf16 v[80:95], v[136:139], v[76:79], v[80:95]
  s_waitcnt lgkmcnt(0)
  v_exp_f32 v2, v2
  v_exp_f32 v3, v3
  v_exp_f32 v4, v4
  v_exp_f32 v5, v5
  v_mfma_f32_32x32x16_bf16 v[32:47], v[96:99], v[140:143], 0
  ds_read_b128 v[96:99], v148 offset:0
  v_exp_f32 v6, v6
  v_exp_f32 v7, v7
  v_cvt_pk_bf16_f32 v64, v0, v1
  v_cvt_pk_bf16_f32 v65, v2, v3
  v_cvt_pk_bf16_f32 v66, v4, v5
  v_cvt_pk_bf16_f32 v67, v6, v7
  v_exp_f32 v8, v8
  v_mfma_f32_32x32x16_bf16 v[48:63], v[100:103], v[140:143], 0
  ds_read_b128 v[100:103], v148 offset:2560
  v_exp_f32 v9, v9
  v_exp_f32 v10, v10
  v_exp_f32 v11, v11
  v_exp_f32 v12, v12
  s_mov_b64 exec, s[40:41]
  v_mfma_f32_32x32x16_bf16 v[80:95], v[108:111], v[64:67], v[80:95]
  ds_read_b128 v[124:127], v153 offset:56320
  ds_read_b128 v[128:131], v153 offset:56960
  ds_read_b128 v[132:135], v153 offset:58880
  ds_read_b128 v[136:139], v153 offset:59520
  s_mov_b64 exec, -1
  v_exp_f32 v13, v13
  v_exp_f32 v14, v14
  v_exp_f32 v15, v15
  v_cvt_pk_bf16_f32 v68, v8, v9
  v_cvt_pk_bf16_f32 v69, v10, v11
  v_cvt_pk_bf16_f32 v70, v12, v13
  v_cvt_pk_bf16_f32 v71, v14, v15
  v_mfma_f32_32x32x4_2b_bf16 v[32:63], v[104:105], v[144:145], v[32:63]
  ds_read_b64 v[104:105], v151 offset:0
  v_exp_f32 v16, v16
  v_exp_f32 v17, v17
  v_exp_f32 v18, v18
  v_exp_f32 v19, v19
  v_exp_f32 v20, v20
  v_exp_f32 v21, v21
  v_exp_f32 v22, v22
  v_exp_f32 v23, v23
  s_add_u32 m0, s73, 4096
  v_mfma_f32_32x32x16_bf16 v[80:95], v[112:115], v[68:71], v[80:95]
  buffer_load_dwordx4 v172, s[12:15], s70 offen lds
  v_cvt_pk_bf16_f32 v72, v16, v17
  v_cvt_pk_bf16_f32 v73, v18, v19
  v_cvt_pk_bf16_f32 v74, v20, v21
  v_cvt_pk_bf16_f32 v75, v22, v23
  v_exp_f32 v24, v24
  v_exp_f32 v25, v25
  s_add_u32 m0, s73, 5120
  v_mfma_f32_32x32x16_bf16 v[80:95], v[116:119], v[72:75], v[80:95]
  buffer_load_dwordx4 v168, s[12:15], s71 offen lds
  v_exp_f32 v26, v26
  v_exp_f32 v27, v27
  v_exp_f32 v28, v28
  v_exp_f32 v29, v29
  v_exp_f32 v30, v30
  v_exp_f32 v31, v31
  v_cvt_pk_bf16_f32 v76, v24, v25
  v_cvt_pk_bf16_f32 v77, v26, v27
  v_cvt_pk_bf16_f32 v78, v28, v29
  v_cvt_pk_bf16_f32 v79, v30, v31
  s_setprio 0
  v_exp_f32 v32, v32
  v_exp_f32 v33, v33
  v_mfma_f32_32x32x16_bf16 v[80:95], v[120:123], v[76:79], v[80:95]
  s_waitcnt lgkmcnt(0)
  v_exp_f32 v34, v34
  v_exp_f32 v35, v35
  v_exp_f32 v36, v36
  v_exp_f32 v37, v37
  v_mfma_f32_32x32x16_bf16 v[0:15], v[96:99], v[140:143], 0
  ds_read_b128 v[96:99], v148 offset:5120
  v_exp_f32 v38, v38
  v_exp_f32 v39, v39
  v_cvt_pk_bf16_f32 v64, v32, v33
  v_cvt_pk_bf16_f32 v65, v34, v35
  v_cvt_pk_bf16_f32 v66, v36, v37
  v_cvt_pk_bf16_f32 v67, v38, v39
  v_exp_f32 v40, v40
  v_mfma_f32_32x32x16_bf16 v[16:31], v[100:103], v[140:143], 0
  ds_read_b128 v[100:103], v148 offset:7680
  v_exp_f32 v41, v41
  v_exp_f32 v42, v42
  v_exp_f32 v43, v43
  v_exp_f32 v44, v44
  s_mov_b64 exec, s[40:41]
  v_mfma_f32_32x32x16_bf16 v[80:95], v[124:127], v[64:67], v[80:95]
  ds_read_b128 v[108:111], v154 offset:0
  ds_read_b128 v[112:115], v154 offset:640
  ds_read_b128 v[116:119], v154 offset:2560
  ds_read_b128 v[120:123], v154 offset:3200
  s_mov_b64 exec, -1
  v_exp_f32 v45, v45
  v_exp_f32 v46, v46
  v_exp_f32 v47, v47
  v_cvt_pk_bf16_f32 v68, v40, v41
  v_cvt_pk_bf16_f32 v69, v42, v43
  v_cvt_pk_bf16_f32 v70, v44, v45
  v_cvt_pk_bf16_f32 v71, v46, v47
  v_mfma_f32_32x32x4_2b_bf16 v[0:31], v[104:105], v[144:145], v[0:31]
  ds_read_b64 v[104:105], v151 offset:5120
  v_exp_f32 v48, v48
  v_exp_f32 v49, v49
  v_exp_f32 v50, v50
  v_exp_f32 v51, v51
  v_exp_f32 v52, v52
  v_exp_f32 v53, v53
  v_exp_f32 v54, v54
  v_exp_f32 v55, v55
  s_add_u32 m0, s73, 6144
  v_mfma_f32_32x32x16_bf16 v[80:95], v[128:131], v[68:71], v[80:95]
  buffer_load_dwordx4 v169, s[12:15], s71 offen lds
  v_cvt_pk_bf16_f32 v72, v48, v49
  v_cvt_pk_bf16_f32 v73, v50, v51
  v_cvt_pk_bf16_f32 v74, v52, v53
  v_cvt_pk_bf16_f32 v75, v54, v55
  v_exp_f32 v56, v56
  v_exp_f32 v57, v57
  s_add_u32 m0, s73, 7168
  v_mfma_f32_32x32x16_bf16 v[80:95], v[132:135], v[72:75], v[80:95]
  buffer_load_dwordx4 v170, s[12:15], s71 offen lds
  v_exp_f32 v58, v58
  v_exp_f32 v59, v59
  v_exp_f32 v60, v60
  v_exp_f32 v61, v61
  v_exp_f32 v62, v62
  v_exp_f32 v63, v63
  v_cvt_pk_bf16_f32 v76, v56, v57
  v_cvt_pk_bf16_f32 v77, v58, v59
  v_cvt_pk_bf16_f32 v78, v60, v61
  v_cvt_pk_bf16_f32 v79, v62, v63
  s_setprio 3
  buffer_load_dwordx4 v[164:167], v163, s[20:23], s9 offen sc1
  buffer_load_dword v161, v162, s[20:23], s9 offen offset:128 sc1
  v_exp_f32 v0, v0
  v_exp_f32 v1, v1
  v_mfma_f32_32x32x16_bf16 v[80:95], v[136:139], v[76:79], v[80:95]
  s_waitcnt lgkmcnt(0)
  v_exp_f32 v2, v2
  v_exp_f32 v3, v3
  v_exp_f32 v4, v4
  v_exp_f32 v5, v5
  v_mfma_f32_32x32x16_bf16 v[32:47], v[96:99], v[140:143], 0
  ds_read_b128 v[96:99], v148 offset:10240
  v_exp_f32 v6, v6
  v_exp_f32 v7, v7
  v_cvt_pk_bf16_f32 v64, v0, v1
  v_cvt_pk_bf16_f32 v65, v2, v3
  v_cvt_pk_bf16_f32 v66, v4, v5
  v_cvt_pk_bf16_f32 v67, v6, v7
  v_exp_f32 v8, v8
  v_mfma_f32_32x32x16_bf16 v[48:63], v[100:103], v[140:143], 0
  ds_read_b128 v[100:103], v148 offset:12800
  v_exp_f32 v9, v9
  v_exp_f32 v10, v10
  v_exp_f32 v11, v11
  v_exp_f32 v12, v12
  s_mov_b64 exec, s[40:41]
  v_mfma_f32_32x32x16_bf16 v[80:95], v[108:111], v[64:67], v[80:95]
  ds_read_b128 v[124:127], v154 offset:5120
  ds_read_b128 v[128:131], v154 offset:5760
  ds_read_b128 v[132:135], v154 offset:7680
  ds_read_b128 v[136:139], v154 offset:8320
  s_mov_b64 exec, -1
  v_exp_f32 v13, v13
  v_exp_f32 v14, v14
  v_exp_f32 v15, v15
  v_cvt_pk_bf16_f32 v68, v8, v9
  v_cvt_pk_bf16_f32 v69, v10, v11
  v_cvt_pk_bf16_f32 v70, v12, v13
  v_cvt_pk_bf16_f32 v71, v14, v15
  v_mfma_f32_32x32x4_2b_bf16 v[32:63], v[104:105], v[144:145], v[32:63]
  ds_read_b64 v[104:105], v151 offset:10240
  v_exp_f32 v16, v16
  v_exp_f32 v17, v17
  v_exp_f32 v18, v18
  v_exp_f32 v19, v19
  v_exp_f32 v20, v20
  v_exp_f32 v21, v21
  v_exp_f32 v22, v22
  v_exp_f32 v23, v23
  s_add_u32 m0, s73, 8192
  v_mfma_f32_32x32x16_bf16 v[80:95], v[112:115], v[68:71], v[80:95]
  buffer_load_dwordx4 v171, s[12:15], s71 offen lds
  v_cvt_pk_bf16_f32 v72, v16, v17
  v_cvt_pk_bf16_f32 v73, v18, v19
  v_cvt_pk_bf16_f32 v74, v20, v21
  v_cvt_pk_bf16_f32 v75, v22, v23
  v_exp_f32 v24, v24
  v_exp_f32 v25, v25
  s_add_u32 m0, s73, 9216
  v_mfma_f32_32x32x16_bf16 v[80:95], v[116:119], v[72:75], v[80:95]
  buffer_load_dwordx4 v172, s[12:15], s71 offen lds
  v_exp_f32 v26, v26
  v_exp_f32 v27, v27
  v_exp_f32 v28, v28
  v_exp_f32 v29, v29
  v_exp_f32 v30, v30
  v_exp_f32 v31, v31
  v_cvt_pk_bf16_f32 v76, v24, v25
  v_cvt_pk_bf16_f32 v77, v26, v27
  v_cvt_pk_bf16_f32 v78, v28, v29
  v_cvt_pk_bf16_f32 v79, v30, v31
  s_setprio 2
  v_exp_f32 v32, v32
  v_exp_f32 v33, v33
  v_mfma_f32_32x32x16_bf16 v[80:95], v[120:123], v[76:79], v[80:95]
  s_waitcnt lgkmcnt(0)
  v_exp_f32 v34, v34
  v_exp_f32 v35, v35
  v_exp_f32 v36, v36
  v_exp_f32 v37, v37
  v_mfma_f32_32x32x16_bf16 v[0:15], v[96:99], v[140:143], 0
  ds_read_b128 v[96:99], v148 offset:15360
  v_exp_f32 v38, v38
  v_exp_f32 v39, v39
  v_cvt_pk_bf16_f32 v64, v32, v33
  v_cvt_pk_bf16_f32 v65, v34, v35
  v_cvt_pk_bf16_f32 v66, v36, v37
  v_cvt_pk_bf16_f32 v67, v38, v39
  v_exp_f32 v40, v40
  v_mfma_f32_32x32x16_bf16 v[16:31], v[100:103], v[140:143], 0
  ds_read_b128 v[100:103], v148 offset:17920
  v_exp_f32 v41, v41
  v_exp_f32 v42, v42
  v_exp_f32 v43, v43
  v_exp_f32 v44, v44
  s_mov_b64 exec, s[40:41]
  v_mfma_f32_32x32x16_bf16 v[80:95], v[124:127], v[64:67], v[80:95]
  ds_read_b128 v[108:111], v154 offset:10240
  ds_read_b128 v[112:115], v154 offset:10880
  ds_read_b128 v[116:119], v154 offset:12800
  ds_read_b128 v[120:123], v154 offset:13440
  s_mov_b64 exec, -1
  v_exp_f32 v45, v45
  v_exp_f32 v46, v46
  v_exp_f32 v47, v47
  v_cvt_pk_bf16_f32 v68, v40, v41
  v_cvt_pk_bf16_f32 v69, v42, v43
  v_cvt_pk_bf16_f32 v70, v44, v45
  v_cvt_pk_bf16_f32 v71, v46, v47
  v_mfma_f32_32x32x4_2b_bf16 v[0:31], v[104:105], v[144:145], v[0:31]
  ds_read_b64 v[104:105], v151 offset:15360
  v_exp_f32 v48, v48
  v_exp_f32 v49, v49
  v_exp_f32 v50, v50
  v_exp_f32 v51, v51
  v_exp_f32 v52, v52
  v_exp_f32 v53, v53
  v_exp_f32 v54, v54
  v_exp_f32 v55, v55
  s_add_u32 m0, s73, 10240
  v_mfma_f32_32x32x16_bf16 v[80:95], v[128:131], v[68:71], v[80:95]
  buffer_load_dwordx4 v168, s[12:15], s72 offen lds
  v_cvt_pk_bf16_f32 v72, v48, v49
  v_cvt_pk_bf16_f32 v73, v50, v51
  v_cvt_pk_bf16_f32 v74, v52, v53
  v_cvt_pk_bf16_f32 v75, v54, v55
  v_exp_f32 v56, v56
  v_exp_f32 v57, v57
  s_add_u32 m0, s73, 11264
  v_mfma_f32_32x32x16_bf16 v[80:95], v[132:135], v[72:75], v[80:95]
  buffer_load_dwordx4 v169, s[12:15], s72 offen lds
  v_exp_f32 v58, v58
  v_exp_f32 v59, v59
  v_exp_f32 v60, v60
  v_exp_f32 v61, v61
  v_exp_f32 v62, v62
  v_exp_f32 v63, v63
  v_cvt_pk_bf16_f32 v76, v56, v57
  v_cvt_pk_bf16_f32 v77, v58, v59
  v_cvt_pk_bf16_f32 v78, v60, v61
  v_cvt_pk_bf16_f32 v79, v62, v63
  s_setprio 1
  v_exp_f32 v0, v0
  v_exp_f32 v1, v1
  v_mfma_f32_32x32x16_bf16 v[80:95], v[136:139], v[76:79], v[80:95]
  s_waitcnt lgkmcnt(0)
  v_exp_f32 v2, v2
  v_exp_f32 v3, v3
  v_exp_f32 v4, v4
  v_exp_f32 v5, v5
  v_mfma_f32_32x32x16_bf16 v[32:47], v[96:99], v[140:143], 0
  ds_read_b128 v[96:99], v148 offset:20480
  v_exp_f32 v6, v6
  v_exp_f32 v7, v7
  v_cvt_pk_bf16_f32 v64, v0, v1
  v_cvt_pk_bf16_f32 v65, v2, v3
  v_cvt_pk_bf16_f32 v66, v4, v5
  v_cvt_pk_bf16_f32 v67, v6, v7
  v_exp_f32 v8, v8
  v_mfma_f32_32x32x16_bf16 v[48:63], v[100:103], v[140:143], 0
  ds_read_b128 v[100:103], v148 offset:23040
  v_exp_f32 v9, v9
  v_exp_f32 v10, v10
  v_exp_f32 v11, v11
  v_exp_f32 v12, v12
  s_mov_b64 exec, s[40:41]
  v_mfma_f32_32x32x16_bf16 v[80:95], v[108:111], v[64:67], v[80:95]
  ds_read_b128 v[124:127], v154 offset:15360
  ds_read_b128 v[128:131], v154 offset:16000
  ds_read_b128 v[132:135], v154 offset:17920
  ds_read_b128 v[136:139], v154 offset:18560
  s_mov_b64 exec, -1
  v_exp_f32 v13, v13
  v_exp_f32 v14, v14
  v_exp_f32 v15, v15
  v_cvt_pk_bf16_f32 v68, v8, v9
  v_cvt_pk_bf16_f32 v69, v10, v11
  v_cvt_pk_bf16_f32 v70, v12, v13
  v_cvt_pk_bf16_f32 v71, v14, v15
  v_mfma_f32_32x32x4_2b_bf16 v[32:63], v[104:105], v[144:145], v[32:63]
  ds_read_b64 v[104:105], v151 offset:20480
  v_exp_f32 v16, v16
  v_exp_f32 v17, v17
  v_exp_f32 v18, v18
  v_exp_f32 v19, v19
  v_exp_f32 v20, v20
  v_exp_f32 v21, v21
  v_exp_f32 v22, v22
  v_exp_f32 v23, v23
  s_add_u32 m0, s73, 12288
  v_mfma_f32_32x32x16_bf16 v[80:95], v[112:115], v[68:71], v[80:95]
  buffer_load_dwordx4 v170, s[12:15], s72 offen lds
  v_cvt_pk_bf16_f32 v72, v16, v17
  v_cvt_pk_bf16_f32 v73, v18, v19
  v_cvt_pk_bf16_f32 v74, v20, v21
  v_cvt_pk_bf16_f32 v75, v22, v23
  v_exp_f32 v24, v24
  v_exp_f32 v25, v25
  v_mfma_f32_32x32x16_bf16 v[80:95], v[116:119], v[72:75], v[80:95]
  buffer_load_dwordx4 v[198:201], v173, s[44:47], s74 offen offset:0
  v_exp_f32 v26, v26
  v_exp_f32 v27, v27
  v_exp_f32 v28, v28
  v_exp_f32 v29, v29
  v_exp_f32 v30, v30
  v_exp_f32 v31, v31
  v_cvt_pk_bf16_f32 v76, v24, v25
  v_cvt_pk_bf16_f32 v77, v26, v27
  v_cvt_pk_bf16_f32 v78, v28, v29
  v_cvt_pk_bf16_f32 v79, v30, v31
  s_setprio 0
  v_exp_f32 v32, v32
  v_exp_f32 v33, v33
  v_mfma_f32_32x32x16_bf16 v[80:95], v[120:123], v[76:79], v[80:95]
  s_waitcnt lgkmcnt(0)
  v_exp_f32 v34, v34
  v_exp_f32 v35, v35
  v_exp_f32 v36, v36
  v_exp_f32 v37, v37
  v_mfma_f32_32x32x16_bf16 v[0:15], v[96:99], v[140:143], 0
  ds_read_b128 v[96:99], v148 offset:25600
  v_exp_f32 v38, v38
  v_exp_f32 v39, v39
  v_cvt_pk_bf16_f32 v64, v32, v33
  v_cvt_pk_bf16_f32 v65, v34, v35
  v_cvt_pk_bf16_f32 v66, v36, v37
  v_cvt_pk_bf16_f32 v67, v38, v39
  v_exp_f32 v40, v40
  v_mfma_f32_32x32x16_bf16 v[16:31], v[100:103], v[140:143], 0
  ds_read_b128 v[100:103], v148 offset:28160
  v_exp_f32 v41, v41
  v_exp_f32 v42, v42
  v_exp_f32 v43, v43
  v_exp_f32 v44, v44
  s_mov_b64 exec, s[40:41]
  v_mfma_f32_32x32x16_bf16 v[80:95], v[124:127], v[64:67], v[80:95]
  ds_read_b128 v[108:111], v154 offset:20480
  ds_read_b128 v[112:115], v154 offset:21120
  ds_read_b128 v[116:119], v154 offset:23040
  ds_read_b128 v[120:123], v154 offset:23680
  s_mov_b64 exec, -1
  v_exp_f32 v45, v45
  v_exp_f32 v46, v46
  v_exp_f32 v47, v47
  v_cvt_pk_bf16_f32 v68, v40, v41
  v_cvt_pk_bf16_f32 v69, v42, v43
  v_cvt_pk_bf16_f32 v70, v44, v45
  v_cvt_pk_bf16_f32 v71, v46, v47
  v_mfma_f32_32x32x4_2b_bf16 v[0:31], v[104:105], v[144:145], v[0:31]
  ds_read_b64 v[104:105], v151 offset:25600
  v_exp_f32 v48, v48
  v_exp_f32 v49, v49
  v_exp_f32 v50, v50
  v_exp_f32 v51, v51
  v_exp_f32 v52, v52
  v_exp_f32 v53, v53
  v_exp_f32 v54, v54
  v_exp_f32 v55, v55
  v_mfma_f32_32x32x16_bf16 v[80:95], v[128:131], v[68:71], v[80:95]
  buffer_load_dwordx4 v[202:205], v173, s[44:47], s74 offen offset:3456
  v_cvt_pk_bf16_f32 v72, v48, v49
  v_cvt_pk_bf16_f32 v73, v50, v51
  v_cvt_pk_bf16_f32 v74, v52, v53
  v_cvt_pk_bf16_f32 v75, v54, v55
  v_exp_f32 v56, v56
  v_exp_f32 v57, v57
  v_mfma_f32_32x32x16_bf16 v[80:95], v[132:135], v[72:75], v[80:95]
  v_exp_f32 v58, v58
  v_exp_f32 v59, v59
  v_exp_f32 v60, v60
  v_exp_f32 v61, v61
  v_exp_f32 v62, v62
  v_exp_f32 v63, v63
  v_cvt_pk_bf16_f32 v76, v56, v57
  v_cvt_pk_bf16_f32 v77, v58, v59
  v_cvt_pk_bf16_f32 v78, v60, v61
  v_cvt_pk_bf16_f32 v79, v62, v63
  s_setprio 3
  v_exp_f32 v0, v0
  v_exp_f32 v1, v1
  v_mfma_f32_32x32x16_bf16 v[80:95], v[136:139], v[76:79], v[80:95]
  s_waitcnt lgkmcnt(0)
  v_exp_f32 v2, v2
  v_exp_f32 v3, v3
  v_exp_f32 v4, v4
  v_exp_f32 v5, v5
  v_mfma_f32_32x32x16_bf16 v[32:47], v[96:99], v[140:143], 0
  ds_read_b128 v[96:99], v148 offset:30720
  v_exp_f32 v6, v6
  v_exp_f32 v7, v7
  v_cvt_pk_bf16_f32 v64, v0, v1
  v_cvt_pk_bf16_f32 v65, v2, v3
  v_cvt_pk_bf16_f32 v66, v4, v5
  v_cvt_pk_bf16_f32 v67, v6, v7
  v_exp_f32 v8, v8
  v_mfma_f32_32x32x16_bf16 v[48:63], v[100:103], v[140:143], 0
  ds_read_b128 v[100:103], v148 offset:33280
  v_exp_f32 v9, v9
  v_exp_f32 v10, v10
  v_exp_f32 v11, v11
  v_exp_f32 v12, v12
  s_mov_b64 exec, s[40:41]
  v_mfma_f32_32x32x16_bf16 v[80:95], v[108:111], v[64:67], v[80:95]
  ds_read_b128 v[124:127], v154 offset:25600
  ds_read_b128 v[128:131], v154 offset:26240
  ds_read_b128 v[132:135], v154 offset:28160
  ds_read_b128 v[136:139], v154 offset:28800
  s_mov_b64 exec, -1
  v_exp_f32 v13, v13
  v_exp_f32 v14, v14
  v_exp_f32 v15, v15
  v_cvt_pk_bf16_f32 v68, v8, v9
  v_cvt_pk_bf16_f32 v69, v10, v11
  v_cvt_pk_bf16_f32 v70, v12, v13
  v_cvt_pk_bf16_f32 v71, v14, v15
  v_mfma_f32_32x32x4_2b_bf16 v[32:63], v[104:105], v[144:145], v[32:63]
  ds_read_b64 v[104:105], v151 offset:30720
  v_exp_f32 v16, v16
  v_exp_f32 v17, v17
  v_exp_f32 v18, v18
  v_exp_f32 v19, v19
  v_exp_f32 v20, v20
  v_exp_f32 v21, v21
  v_exp_f32 v22, v22
  v_exp_f32 v23, v23
  v_mfma_f32_32x32x16_bf16 v[80:95], v[112:115], v[68:71], v[80:95]
  v_cvt_pk_bf16_f32 v72, v16, v17
  v_cvt_pk_bf16_f32 v73, v18, v19
  v_cvt_pk_bf16_f32 v74, v20, v21
  v_cvt_pk_bf16_f32 v75, v22, v23
  v_exp_f32 v24, v24
  v_exp_f32 v25, v25
  v_mfma_f32_32x32x16_bf16 v[80:95], v[116:119], v[72:75], v[80:95]
  v_exp_f32 v26, v26
  v_exp_f32 v27, v27
  v_exp_f32 v28, v28
  v_exp_f32 v29, v29
  v_exp_f32 v30, v30
  v_exp_f32 v31, v31
  v_cvt_pk_bf16_f32 v76, v24, v25
  v_cvt_pk_bf16_f32 v77, v26, v27
  v_cvt_pk_bf16_f32 v78, v28, v29
  v_cvt_pk_bf16_f32 v79, v30, v31
  s_setprio 2
  v_exp_f32 v32, v32
  v_exp_f32 v33, v33
  v_mfma_f32_32x32x16_bf16 v[80:95], v[120:123], v[76:79], v[80:95]
  s_waitcnt lgkmcnt(0)
  v_exp_f32 v34, v34
  v_exp_f32 v35, v35
  v_exp_f32 v36, v36
  v_exp_f32 v37, v37
  v_mfma_f32_32x32x16_bf16 v[0:15], v[96:99], v[140:143], 0
  ds_read_b128 v[96:99], v148 offset:35840
  v_exp_f32 v38, v38
  v_exp_f32 v39, v39
  v_cvt_pk_bf16_f32 v64, v32, v33
  v_cvt_pk_bf16_f32 v65, v34, v35
  v_cvt_pk_bf16_f32 v66, v36, v37
  v_cvt_pk_bf16_f32 v67, v38, v39
  v_exp_f32 v40, v40
  v_mfma_f32_32x32x16_bf16 v[16:31], v[100:103], v[140:143], 0
  ds_read_b128 v[100:103], v148 offset:38400
  v_exp_f32 v41, v41
  v_exp_f32 v42, v42
  v_exp_f32 v43, v43
  v_exp_f32 v44, v44
  s_mov_b64 exec, s[40:41]
  v_mfma_f32_32x32x16_bf16 v[80:95], v[124:127], v[64:67], v[80:95]
  ds_read_b128 v[108:111], v154 offset:30720
  ds_read_b128 v[112:115], v154 offset:31360
  ds_read_b128 v[116:119], v154 offset:33280
  ds_read_b128 v[120:123], v154 offset:33920
  s_mov_b64 exec, -1
  v_exp_f32 v45, v45
  v_exp_f32 v46, v46
  v_exp_f32 v47, v47
  v_cvt_pk_bf16_f32 v68, v40, v41
  v_cvt_pk_bf16_f32 v69, v42, v43
  v_cvt_pk_bf16_f32 v70, v44, v45
  v_cvt_pk_bf16_f32 v71, v46, v47
  v_mfma_f32_32x32x4_2b_bf16 v[0:31], v[104:105], v[144:145], v[0:31]
  ds_read_b64 v[104:105], v151 offset:35840
  v_exp_f32 v48, v48
  v_exp_f32 v49, v49
  v_exp_f32 v50, v50
  v_exp_f32 v51, v51
  v_exp_f32 v52, v52
  v_exp_f32 v53, v53
  v_exp_f32 v54, v54
  v_exp_f32 v55, v55
  v_mfma_f32_32x32x16_bf16 v[80:95], v[128:131], v[68:71], v[80:95]
  v_cvt_pk_bf16_f32 v72, v48, v49
  v_cvt_pk_bf16_f32 v73, v50, v51
  v_cvt_pk_bf16_f32 v74, v52, v53
  v_cvt_pk_bf16_f32 v75, v54, v55
  v_exp_f32 v56, v56
  v_exp_f32 v57, v57
  v_mfma_f32_32x32x16_bf16 v[80:95], v[132:135], v[72:75], v[80:95]
  v_exp_f32 v58, v58
  v_exp_f32 v59, v59
  v_exp_f32 v60, v60
  v_exp_f32 v61, v61
  v_exp_f32 v62, v62
  v_exp_f32 v63, v63
  v_cvt_pk_bf16_f32 v76, v56, v57
  v_cvt_pk_bf16_f32 v77, v58, v59
  v_cvt_pk_bf16_f32 v78, v60, v61
  v_cvt_pk_bf16_f32 v79, v62, v63
  s_setprio 1
  s_waitcnt vmcnt(7)
sequential_preLN__mha_block__moe_arch_mod__prompt_kernel_dchk86:
  v_or3_b32 v164, v164, v165, v166
  v_or_b32 v164, v164, v167
  v_cmp_lt_u32 vcc, 47, v164
  s_nop 4
  s_cbranch_vccz sequential_preLN__mha_block__moe_arch_mod__prompt_kernel_dsk88
  s_sub_u32 s75, s75, 1
  s_cbranch_scc1 sequential_preLN__mha_block__moe_arch_mod__prompt_kernel_end1
  buffer_load_dwordx4 v[164:167], v163, s[20:23], s9 offen sc1
  s_waitcnt vmcnt(0)
  s_branch sequential_preLN__mha_block__moe_arch_mod__prompt_kernel_dchk86
sequential_preLN__mha_block__moe_arch_mod__prompt_kernel_dsk88:
  v_cmp_eq_u32 vcc, -1, v161
  s_nop 4
  s_cbranch_vccz sequential_preLN__mha_block__moe_arch_mod__prompt_kernel_dok87
  s_sub_u32 s75, s75, 1
  s_cbranch_scc1 sequential_preLN__mha_block__moe_arch_mod__prompt_kernel_end1
  buffer_load_dword v161, v162, s[20:23], s9 offen offset:128 sc1
  s_waitcnt vmcnt(0)
  s_branch sequential_preLN__mha_block__moe_arch_mod__prompt_kernel_dsk88
sequential_preLN__mha_block__moe_arch_mod__prompt_kernel_dok87:
  v_subrev_u32 v164, 32, v177
  v_cmp_ne_u32 vcc, v164, v161
  v_exp_f32 v0, v0
  v_exp_f32 v1, v1
  s_cmp_lg_u64 vcc, 0
  s_cselect_b32 s101, 1, 0
  v_mfma_f32_32x32x16_bf16 v[80:95], v[136:139], v[76:79], v[80:95]
  s_waitcnt lgkmcnt(0)
  v_exp_f32 v2, v2
  v_exp_f32 v3, v3
  v_exp_f32 v4, v4
  v_exp_f32 v5, v5
  v_mfma_f32_32x32x16_bf16 v[32:47], v[96:99], v[140:143], 0
  v_exp_f32 v6, v6
  v_exp_f32 v7, v7
  v_cvt_pk_bf16_f32 v64, v0, v1
  v_cvt_pk_bf16_f32 v65, v2, v3
  v_cvt_pk_bf16_f32 v66, v4, v5
  v_cvt_pk_bf16_f32 v67, v6, v7
  v_exp_f32 v8, v8
  v_mfma_f32_32x32x16_bf16 v[48:63], v[100:103], v[140:143], 0
  v_exp_f32 v9, v9
  v_exp_f32 v10, v10
  v_exp_f32 v11, v11
  v_exp_f32 v12, v12
  s_mov_b64 exec, s[40:41]
  v_mfma_f32_32x32x16_bf16 v[80:95], v[108:111], v[64:67], v[80:95]
  ds_read_b128 v[124:127], v154 offset:35840
  ds_read_b128 v[128:131], v154 offset:36480
  ds_read_b128 v[132:135], v154 offset:38400
  ds_read_b128 v[136:139], v154 offset:39040
  s_mov_b64 exec, -1
  v_exp_f32 v13, v13
  v_exp_f32 v14, v14
  v_exp_f32 v15, v15
  v_cvt_pk_bf16_f32 v68, v8, v9
  v_cvt_pk_bf16_f32 v69, v10, v11
  v_cvt_pk_bf16_f32 v70, v12, v13
  v_cvt_pk_bf16_f32 v71, v14, v15
  v_mfma_f32_32x32x4_2b_bf16 v[32:63], v[104:105], v[144:145], v[32:63]
  v_exp_f32 v16, v16
  v_exp_f32 v17, v17
  v_exp_f32 v18, v18
  v_exp_f32 v19, v19
  v_exp_f32 v20, v20
  v_exp_f32 v21, v21
  v_exp_f32 v22, v22
  v_exp_f32 v23, v23
  v_mfma_f32_32x32x16_bf16 v[80:95], v[112:115], v[68:71], v[80:95]
  v_cvt_pk_bf16_f32 v72, v16, v17
  v_cvt_pk_bf16_f32 v73, v18, v19
  v_cvt_pk_bf16_f32 v74, v20, v21
  v_cvt_pk_bf16_f32 v75, v22, v23
  v_exp_f32 v24, v24
  v_exp_f32 v25, v25
  v_mfma_f32_32x32x16_bf16 v[80:95], v[116:119], v[72:75], v[80:95]
  v_exp_f32 v26, v26
  v_exp_f32 v27, v27
  v_exp_f32 v28, v28
  v_exp_f32 v29, v29
  v_exp_f32 v30, v30
  v_exp_f32 v31, v31
  v_cvt_pk_bf16_f32 v76, v24, v25
  v_cvt_pk_bf16_f32 v77, v26, v27
  v_cvt_pk_bf16_f32 v78, v28, v29
  v_cvt_pk_bf16_f32 v79, v30, v31
  s_setprio 0
  v_exp_f32 v32, v32
  v_exp_f32 v33, v33
  v_mfma_f32_32x32x16_bf16 v[80:95], v[120:123], v[76:79], v[80:95]
  s_mov_b64 s[72:73], 0
  s_and_b32 s70, s2, 7
  s_cmp_eq_u32 s25, s70
  s_cselect_b32 s71, s101, 1
  s_lshr_b32 s3, s74, 4
  s_add_u32 s3, s3, s70
  s_lshl_b32 s54, s3, 6
  s_add_u32 s54, s54, 16076800
  s_cmp_eq_u32 s101, 1
  s_cbranch_scc1 sequential_preLN__mha_block__moe_arch_mod__prompt_kernel_pd89
  v_mov_b32 v240, -1
  v_mov_b32 v241, -1
  v_mov_b32 v242, -1
  v_mov_b32 v243, -1
  v_lshrrev_b32 v244, 3, v159
  v_lshlrev_b32 v244, 4, v244
  s_lshl_b32 s3, s24, 13
  s_lshl_b32 s55, s25, 10
  s_add_u32 s3, s3, s55
  s_add_u32 s3, s3, 15728640
  buffer_store_dwordx4 v[240:243], v244, s[20:23], s3 offen
  s_mul_i32 s3, s70, 40
  v_subrev_u32 v245, s3, v159
  v_cmp_gt_u32 s[72:73], 40, v245
  v_lshrrev_b32 v245, 3, v159
  v_mul_u32_u24 v245, 14336, v245
  v_and_b32 v246, 7, v159
  v_lshl_add_u32 v245, v246, 3, v245
  s_cmp_ge_u32 s2, 216
  s_cselect_b64 exec, 0, s[72:73]
  buffer_store_dwordx2 v[240:241], v245, s[20:23], s54 offen
  s_cmp_ge_u32 s2, 208
  s_cselect_b64 exec, exec, 0
  buffer_store_dwordx2 v[240:241], v245, s[20:23], s54 offen offset:64
  s_mov_b64 exec, -1
  s_cmp_lg_u32 s71, 0
  s_cbranch_scc1 sequential_preLN__mha_block__moe_arch_mod__prompt_kernel_pd89
  buffer_store_dwordx4 v[240:243], v158, s[20:23], s37 offen
  s_mov_b64 exec, 0xffffffff
  buffer_store_dwordx2 v[240:241], v247, s[20:23], s38 offen
  s_mov_b64 exec, -1
  s_cmp_lg_u32 s26, 0
  s_cbranch_scc1 sequential_preLN__mha_block__moe_arch_mod__prompt_kernel_pd89
  s_lshl_b32 s3, s70, 2
  s_lshl_b32 s3, 15, s3
  s_not_b32 s3, s3
  s_and_b32 s55, s24, 3
  s_cselect_b32 s3, 0, s3
  s_bitset1_b32 s3, s24
  s_lshl_b32 s55, s70, 8
  s_add_u32 s55, s55, 15992832
  v_lshlrev_b32 v246, 2, v155
  s_mov_b32 exec_lo, s3
  s_mov_b32 exec_hi, 0
  buffer_store_dword v240, v246, s[20:23], s55 offen
  s_mov_b64 exec, -1
sequential_preLN__mha_block__moe_arch_mod__prompt_kernel_pd89:
  s_waitcnt lgkmcnt(0)
  v_exp_f32 v34, v34
  v_exp_f32 v35, v35
  v_exp_f32 v36, v36
  v_exp_f32 v37, v37
  v_exp_f32 v38, v38
  v_exp_f32 v39, v39
  v_cvt_pk_bf16_f32 v64, v32, v33
  v_cvt_pk_bf16_f32 v65, v34, v35
  v_cvt_pk_bf16_f32 v66, v36, v37
  v_cvt_pk_bf16_f32 v67, v38, v39
  v_exp_f32 v40, v40
  v_exp_f32 v41, v41
  v_exp_f32 v42, v42
  v_exp_f32 v43, v43
  v_exp_f32 v44, v44
  v_mfma_f32_32x32x16_bf16 v[80:95], v[124:127], v[64:67], v[80:95]
  v_exp_f32 v45, v45
  v_exp_f32 v46, v46
  v_exp_f32 v47, v47
  v_cvt_pk_bf16_f32 v68, v40, v41
  v_cvt_pk_bf16_f32 v69, v42, v43
  v_cvt_pk_bf16_f32 v70, v44, v45
  v_cvt_pk_bf16_f32 v71, v46, v47
  v_exp_f32 v48, v48
  v_exp_f32 v49, v49
  v_exp_f32 v50, v50
  v_exp_f32 v51, v51
  v_exp_f32 v52, v52
  v_exp_f32 v53, v53
  v_exp_f32 v54, v54
  v_exp_f32 v55, v55
  v_mfma_f32_32x32x16_bf16 v[80:95], v[128:131], v[68:71], v[80:95]
  v_cvt_pk_bf16_f32 v72, v48, v49
  v_cvt_pk_bf16_f32 v73, v50, v51
  v_cvt_pk_bf16_f32 v74, v52, v53
  v_cvt_pk_bf16_f32 v75, v54, v55
  v_exp_f32 v56, v56
  v_exp_f32 v57, v57
  v_mfma_f32_32x32x16_bf16 v[80:95], v[132:135], v[72:75], v[80:95]
  v_exp_f32 v58, v58
  v_exp_f32 v59, v59
  v_exp_f32 v60, v60
  v_exp_f32 v61, v61
  v_exp_f32 v62, v62
  v_exp_f32 v63, v63
  v_cvt_pk_bf16_f32 v76, v56, v57
  v_cvt_pk_bf16_f32 v77, v58, v59
  v_cvt_pk_bf16_f32 v78, v60, v61
  v_cvt_pk_bf16_f32 v79, v62, v63
  s_nop 1
  v_mfma_f32_32x32x16_bf16 v[80:95], v[136:139], v[76:79], v[80:95]
  s_nop 11
  v_max3_f32 v164, |v80|, |v81|, |v82|
  v_max3_f32 v165, |v83|, |v84|, |v85|
  v_max3_f32 v166, |v86|, |v87|, |v88|
  v_max3_f32 v167, |v89|, |v90|, |v91|
  s_mov_b32 s4, 0x21800000
  s_mov_b32 s5, 0x5d800000
  s_mov_b32 s6, 0x7b800000
  v_max3_f32 v164, v164, v165, v166
  v_cmp_le_f32 s[8:9], s4, v92
  v_max_f32 v164, v164, v167
  v_cmp_ge_f32 s[10:11], s5, v92
  v_cmp_gt_f32 vcc, s6, v164
  s_and_b64 s[8:9], s[8:9], s[10:11]
  s_and_b64 s[8:9], s[8:9], vcc
  s_cmp_eq_u64 s[8:9], -1
  s_cbranch_scc0 sequential_preLN__mha_block__moe_arch_mod__prompt_kernel_slow92
sequential_preLN__mha_block__moe_arch_mod__prompt_kernel_finA91:
  v_rcp_f32 v164, v92
  s_nop 0
  v_mul_f32 v80, v80, v164
  v_mul_f32 v81, v81, v164
  v_mul_f32 v82, v82, v164
  v_mul_f32 v83, v83, v164
  v_mul_f32 v84, v84, v164
  v_mul_f32 v85, v85, v164
  v_mul_f32 v86, v86, v164
  v_mul_f32 v87, v87, v164
  v_mul_f32 v88, v88, v164
  v_mul_f32 v89, v89, v164
  v_mul_f32 v90, v90, v164
  v_mul_f32 v91, v91, v164
  v_cvt_pk_bf16_f32 v80, v80, v81
  v_cvt_pk_bf16_f32 v81, v82, v83
  v_cvt_pk_bf16_f32 v82, v84, v85
  v_cvt_pk_bf16_f32 v83, v86, v87
  v_cvt_pk_bf16_f32 v84, v88, v89
  v_cvt_pk_bf16_f32 v85, v90, v91
  v_min_u32 v80, -2, v80
  v_min_u32 v81, -2, v81
  v_min_u32 v82, -2, v82
  v_min_u32 v83, -2, v83
  v_min_u32 v84, -2, v84
  v_min_u32 v85, -2, v85
  s_cmp_eq_u32 s71, 1
  s_cbranch_scc1 sequential_preLN__mha_block__moe_arch_mod__prompt_kernel_o193
  buffer_store_dwordx4 v[80:83], v158, s[20:23], s37 offen
  s_mov_b64 exec, 0xffffffff
  buffer_store_dwordx2 v[84:85], v247, s[20:23], s38 offen
  s_mov_b64 exec, -1
  s_branch sequential_preLN__mha_block__moe_arch_mod__prompt_kernel_o294
sequential_preLN__mha_block__moe_arch_mod__prompt_kernel_o193:
  buffer_store_dwordx4 v[80:83], v158, s[20:23], s37 offen sc1
  s_mov_b64 exec, 0xffffffff
  buffer_store_dwordx2 v[84:85], v247, s[20:23], s38 offen sc1
  s_mov_b64 exec, -1
sequential_preLN__mha_block__moe_arch_mod__prompt_kernel_o294:
  s_and_b32 s27, s26, 3
  s_lshr_b32 s28, s26, 2
  v_lshrrev_b32 v2, 4, v155
  v_lshlrev_b32 v2, 9, v2
  v_and_b32 v3, 15, v155
  v_lshl_add_u32 v2, v3, 4, v2
  s_and_b32 s3, s27, 1
  s_lshl_b32 s3, s3, 8
  v_add_u32 v118, s3, v2
  s_lshl_b32 s29, s24, 1
  s_lshr_b32 s3, s27, 1
  s_add_u32 s29, s29, s3
  s_mul_i32 s29, s29, 40960
  s_add_u32 s29, s29, 13107200
  s_lshl_b32 s30, s28, 14
  s_add_u32 s30, s30, s29
  s_add_u32 s31, s30, 4096
  s_add_u32 s32, s30, 8192
  s_add_u32 s33, s30, 12288
  s_lshl_b32 s34, s28, 12
  s_add_u32 s34, s34, s29
  s_add_u32 s34, s34, 32768
  v_lshrrev_b32 v3, 3, v159
  v_and_b32 v4, 7, v159
  v_lshlrev_b32 v115, 4, v3
  v_lshl_add_u32 v116, v4, 10, v115
  v_mul_u32_u24 v113, 336, v3
  v_mul_u32_u24 v5, 40, v4
  v_add_u32 v113, v113, v5
  v_add_u32 v113, 102400, v113
  v_lshrrev_b32 v3, 4, v155
  v_bfe_u32 v4, v155, 2, 2
  v_and_b32 v5, 3, v155
  v_lshrrev_b32 v6, 1, v3
  v_and_b32 v7, 1, v3
  v_mul_u32_u24 v8, 20, v6
  v_lshl_add_u32 v8, v7, 2, v8
  v_add_u32 v8, v8, v4
  v_mul_u32_u24 v8, 160, v8
  v_lshl_add_u32 v8, v5, 3, v8
  s_mul_i32 s3, s28, 51200
  v_add_u32 v110, s3, v8
  v_mul_u32_u24 v8, 80, v6
  v_mul_u32_u24 v9, 40, v7
  v_add3_u32 v8, v8, v9, v4
  v_add_u32 v8, 16, v8
  v_mul_u32_u24 v8, 160, v8
  v_lshl_add_u32 v8, v5, 3, v8
  s_mul_i32 s3, s28, 51200
  v_add_u32 v111, s3, v8
  v_and_b32 v4, 15, v155
  s_lshl_b32 s3, s27, 4
  v_add_u32 v4, s3, v4
  v_mul_u32_u24 v4, 336, v4
  v_lshl_add_u32 v4, v3, 4, v4
  s_mul_i32 s3, s28, 21504
  s_add_u32 s3, s3, 102400
  v_add_u32 v114, s3, v4
  s_waitcnt vmcnt(2)
  v_lshlrev_b32 v0, 16, v222
  v_and_b32 v1, 0xffff0000, v222
  v_lshlrev_b32 v2, 16, v223
  v_and_b32 v3, 0xffff0000, v223
  v_add_f32 v0, v0, v2
  v_add_f32 v1, v1, v3
  v_lshlrev_b32 v2, 16, v224
  v_and_b32 v3, 0xffff0000, v224
  v_add_f32 v0, v0, v2
  v_add_f32 v1, v1, v3
  v_lshlrev_b32 v2, 16, v225
  v_and_b32 v3, 0xffff0000, v225
  v_add_f32 v0, v0, v2
  v_add_f32 v1, v1, v3
  v_lshlrev_b32 v2, 16, v226
  v_and_b32 v3, 0xffff0000, v226
  v_add_f32 v0, v0, v2
  v_add_f32 v1, v1, v3
  v_add_f32 v0, v0, v1
  s_nop 1
  v_add_f32_dpp v0, v0, v0 quad_perm:[1,0,3,2] row_mask:0xf bank_mask:0xf
  s_nop 1
  v_add_f32_dpp v0, v0, v0 quad_perm:[2,3,0,1] row_mask:0xf bank_mask:0xf
  s_nop 1
  v_add_f32_dpp v0, v0, v0 row_half_mirror row_mask:0xf bank_mask:0xf
  s_nop 1
  v_add_f32_dpp v0, v0, v0 row_mirror row_mask:0xf bank_mask:0xf
  s_nop 1
  v_add_f32_dpp v0, v0, v0 row_bcast:15 row_mask:0xa bank_mask:0xf
  s_nop 1
  v_add_f32_dpp v0, v0, v0 row_bcast:31 row_mask:0xc bank_mask:0xf
  s_nop 0
  v_readlane_b32 s57, v0, 63
  s_mov_b32 s58, 0x05040100
  s_mov_b32 s59, 0x07060302
  v_perm_b32 v120, v194, v190, s58
  v_perm_b32 v121, v194, v190, s59
  v_perm_b32 v122, v195, v191, s58
  v_perm_b32 v123, v195, v191, s59
  v_perm_b32 v124, v196, v192, s58
  v_perm_b32 v125, v196, v192, s59
  v_perm_b32 v126, v197, v193, s58
  v_perm_b32 v127, v197, v193, s59
  v_mov_b32 v190, v120
  v_mov_b32 v191, v121
  v_mov_b32 v192, v122
  v_mov_b32 v193, v123
  v_mov_b32 v194, v124
  v_mov_b32 v195, v125
  v_mov_b32 v196, v126
  v_mov_b32 v197, v127
  v_perm_b32 v120, v202, v198, s58
  v_perm_b32 v121, v202, v198, s59
  v_perm_b32 v122, v203, v199, s58
  v_perm_b32 v123, v203, v199, s59
  v_perm_b32 v124, v204, v200, s58
  v_perm_b32 v125, v204, v200, s59
  v_perm_b32 v126, v205, v201, s58
  v_perm_b32 v127, v205, v201, s59
  v_mov_b32 v198, v120
  v_mov_b32 v199, v121
  v_mov_b32 v200, v122
  v_mov_b32 v201, v123
  v_mov_b32 v202, v124
  v_mov_b32 v203, v125
  v_mov_b32 v204, v126
  v_mov_b32 v205, v127
  v_perm_b32 v214, v207, v206, s58
  v_perm_b32 v215, v207, v206, s59
  v_perm_b32 v216, v209, v208, s58
  v_perm_b32 v217, v209, v208, s59
  v_perm_b32 v218, v211, v210, s58
  v_perm_b32 v219, v211, v210, s59
  v_perm_b32 v220, v213, v212, s58
  v_perm_b32 v221, v213, v212, s59
  v_lshrrev_b32 v2, 3, v159
  v_mul_u32_u24 v2, 14336, v2
  v_and_b32 v3, 7, v159
  v_lshl_add_u32 v206, v3, 3, v2
  s_barrier
  buffer_load_dwordx4 v[10:13], v118, s[20:23], s30 offen offset:0 sc1
  buffer_load_dwordx4 v[14:17], v118, s[20:23], s30 offen offset:2048 sc1
  buffer_load_dwordx4 v[18:21], v118, s[20:23], s31 offen offset:0 sc1
  buffer_load_dwordx4 v[22:25], v118, s[20:23], s31 offen offset:2048 sc1
  buffer_load_dwordx4 v[26:29], v118, s[20:23], s32 offen offset:0 sc1
  buffer_load_dwordx4 v[30:33], v118, s[20:23], s32 offen offset:2048 sc1
  buffer_load_dwordx4 v[34:37], v118, s[20:23], s33 offen offset:0 sc1
  buffer_load_dwordx4 v[38:41], v118, s[20:23], s33 offen offset:2048 sc1
  buffer_load_dwordx4 v[42:45], v118, s[20:23], s34 offen offset:0 sc1
  buffer_load_dwordx4 v[46:49], v118, s[20:23], s34 offen offset:2048 sc1
  s_and_b32 s35, s2, 7
  s_lshl_b32 s35, s35, 8
  s_add_u32 s35, s35, 15990784
  v_and_b32 v177, 31, v155
  v_lshlrev_b32 v177, 2, v177
  s_lshl_b32 s3, s24, 2
  v_cmp_eq_u32 s[68:69], s3, v177
  v_lshrrev_b32 v2, 4, v177
  s_and_b32 s3, s2, 7
  s_cmp_eq_u32 s101, 1
  s_cselect_b32 s3, -1, s3
  v_cmp_eq_u32 vcc, s3, v2
  v_add_u32 v2, 2048, v177
  s_nop 0
  v_cndmask_b32 v153, v177, v2, vcc
  v_add_u32 v148, 1024, v158
  v_add_u32 v149, 2048, v158
  v_min_u32 v149, 2544, v149
  s_cmp_ge_u32 s2, 216
  s_cselect_b32 s3, -1, 1280
  v_cmp_gt_u32 vcc, s3, v148
  v_mov_b32 v2, 0x80000000
  s_nop 0
  v_cndmask_b32 v150, v2, v148, vcc
  v_cmp_gt_u32 vcc, s3, v149
  s_nop 1
  v_cndmask_b32 v151, v2, v149, vcc
  s_mov_b32 s65, 0
  ds_read_b64_tr_b16 v[70:71], v110 offset:0
  ds_read_b64_tr_b16 v[72:73], v110 offset:1280
  ds_read_b64_tr_b16 v[74:75], v110 offset:32
  ds_read_b64_tr_b16 v[76:77], v110 offset:1312
  ds_read_b64_tr_b16 v[78:79], v110 offset:64
  ds_read_b64_tr_b16 v[80:81], v110 offset:1344
  ds_read_b64_tr_b16 v[82:83], v110 offset:96
  ds_read_b64_tr_b16 v[84:85], v110 offset:1376
  ds_read_b64_tr_b16 v[86:87], v110 offset:128
  ds_read_b64_tr_b16 v[88:89], v110 offset:1408
sequential_preLN__mha_block__moe_arch_mod__prompt_kernel_chk95:
  s_waitcnt vmcnt(0)
  v_max3_u32 v50, v10, v11, v12
  v_max3_u32 v51, v14, v15, v16
  v_max3_u32 v52, v18, v19, v20
  v_max3_u32 v53, v22, v23, v24
  v_max3_u32 v54, v26, v27, v28
  v_max3_u32 v55, v30, v31, v32
  v_max3_u32 v56, v34, v35, v36
  v_max3_u32 v57, v38, v39, v40
  v_max3_u32 v58, v42, v43, v44
  v_max3_u32 v59, v46, v47, v48
  v_max_u32 v50, v50, v13
  v_max_u32 v51, v51, v17
  v_max_u32 v52, v52, v21
  v_max_u32 v53, v53, v25
  v_max_u32 v54, v54, v29
  v_max_u32 v55, v55, v33
  v_max_u32 v56, v56, v37
  v_max_u32 v57, v57, v41
  v_max_u32 v58, v58, v45
  v_max_u32 v59, v59, v49
  v_max3_u32 v0, v50, v51, v52
  v_max3_u32 v1, v53, v54, v55
  v_max3_u32 v2, v56, v57, v58
  v_max3_u32 v0, v0, v1, v59
  v_max_u32 v0, v0, v2
  v_cmp_eq_u32 vcc, -1, v0
  s_nop 4
  s_cbranch_vccz sequential_preLN__mha_block__moe_arch_mod__prompt_kernel_ook96
  s_sub_u32 s75, s75, 1
  s_cbranch_scc1 sequential_preLN__mha_block__moe_arch_mod__prompt_kernel_end1
  v_cmp_eq_u32 vcc, -1, v50
  s_nop 4
  s_cbranch_vccz sequential_preLN__mha_block__moe_arch_mod__prompt_kernel_sk97
  buffer_load_dwordx4 v[10:13], v118, s[20:23], s30 offen offset:0 sc1
sequential_preLN__mha_block__moe_arch_mod__prompt_kernel_sk97:
  v_cmp_eq_u32 vcc, -1, v51
  s_nop 4
  s_cbranch_vccz sequential_preLN__mha_block__moe_arch_mod__prompt_kernel_sk98
  buffer_load_dwordx4 v[14:17], v118, s[20:23], s30 offen offset:2048 sc1
sequential_preLN__mha_block__moe_arch_mod__prompt_kernel_sk98:
  v_cmp_eq_u32 vcc, -1, v52
  s_nop 4
  s_cbranch_vccz sequential_preLN__mha_block__moe_arch_mod__prompt_kernel_sk99
  buffer_load_dwordx4 v[18:21], v118, s[20:23], s31 offen offset:0 sc1
sequential_preLN__mha_block__moe_arch_mod__prompt_kernel_sk99:
  v_cmp_eq_u32 vcc, -1, v53
  s_nop 4
  s_cbranch_vccz sequential_preLN__mha_block__moe_arch_mod__prompt_kernel_sk100
  buffer_load_dwordx4 v[22:25], v118, s[20:23], s31 offen offset:2048 sc1
sequential_preLN__mha_block__moe_arch_mod__prompt_kernel_sk100:
  v_cmp_eq_u32 vcc, -1, v54
  s_nop 4
  s_cbranch_vccz sequential_preLN__mha_block__moe_arch_mod__prompt_kernel_sk101
  buffer_load_dwordx4 v[26:29], v118, s[20:23], s32 offen offset:0 sc1
sequential_preLN__mha_block__moe_arch_mod__prompt_kernel_sk101:
  v_cmp_eq_u32 vcc, -1, v55
  s_nop 4
  s_cbranch_vccz sequential_preLN__mha_block__moe_arch_mod__prompt_kernel_sk102
  buffer_load_dwordx4 v[30:33], v118, s[20:23], s32 offen offset:2048 sc1
sequential_preLN__mha_block__moe_arch_mod__prompt_kernel_sk102:
  v_cmp_eq_u32 vcc, -1, v56
  s_nop 4
  s_cbranch_vccz sequential_preLN__mha_block__moe_arch_mod__prompt_kernel_sk103
  buffer_load_dwordx4 v[34:37], v118, s[20:23], s33 offen offset:0 sc1
sequential_preLN__mha_block__moe_arch_mod__prompt_kernel_sk103:
  v_cmp_eq_u32 vcc, -1, v57
  s_nop 4
  s_cbranch_vccz sequential_preLN__mha_block__moe_arch_mod__prompt_kernel_sk104
  buffer_load_dwordx4 v[38:41], v118, s[20:23], s33 offen offset:2048 sc1
sequential_preLN__mha_block__moe_arch_mod__prompt_kernel_sk104:
  v_cmp_eq_u32 vcc, -1, v58
  s_nop 4
  s_cbranch_vccz sequential_preLN__mha_block__moe_arch_mod__prompt_kernel_sk105
  buffer_load_dwordx4 v[42:45], v118, s[20:23], s34 offen offset:0 sc1
sequential_preLN__mha_block__moe_arch_mod__prompt_kernel_sk105:
  v_cmp_eq_u32 vcc, -1, v59
  s_nop 4
  s_cbranch_vccz sequential_preLN__mha_block__moe_arch_mod__prompt_kernel_sk106
  buffer_load_dwordx4 v[46:49], v118, s[20:23], s34 offen offset:2048 sc1
sequential_preLN__mha_block__moe_arch_mod__prompt_kernel_sk106:
  s_branch sequential_preLN__mha_block__moe_arch_mod__prompt_kernel_chk95
sequential_preLN__mha_block__moe_arch_mod__prompt_kernel_ook96:
  s_waitcnt lgkmcnt(8)
  v_mfma_f32_16x16x32_bf16 v[50:53], v[70:73], v[10:13], 0
  ds_read_b64_tr_b16 v[90:91], v110 offset:6400
  ds_read_b64_tr_b16 v[92:93], v110 offset:7680
  s_waitcnt lgkmcnt(8)
  v_mfma_f32_16x16x32_bf16 v[54:57], v[74:77], v[10:13], 0
  ds_read_b64_tr_b16 v[94:95], v110 offset:6432
  ds_read_b64_tr_b16 v[96:97], v110 offset:7712
  s_waitcnt lgkmcnt(8)
  v_mfma_f32_16x16x32_bf16 v[58:61], v[78:81], v[10:13], 0
  ds_read_b64_tr_b16 v[98:99], v110 offset:6464
  ds_read_b64_tr_b16 v[100:101], v110 offset:7744
  s_waitcnt lgkmcnt(8)
  v_mfma_f32_16x16x32_bf16 v[62:65], v[82:85], v[10:13], 0
  ds_read_b64_tr_b16 v[102:103], v110 offset:6496
  ds_read_b64_tr_b16 v[104:105], v110 offset:7776
  s_waitcnt lgkmcnt(8)
  v_mfma_f32_16x16x32_bf16 v[66:69], v[86:89], v[10:13], 0
  ds_read_b64_tr_b16 v[106:107], v110 offset:6528
  ds_read_b64_tr_b16 v[108:109], v110 offset:7808
  s_waitcnt lgkmcnt(8)
  v_mfma_f32_16x16x32_bf16 v[50:53], v[90:93], v[14:17], v[50:53]
  ds_read_b64_tr_b16 v[70:71], v110 offset:12800
  ds_read_b64_tr_b16 v[72:73], v110 offset:14080
  s_waitcnt lgkmcnt(8)
  v_mfma_f32_16x16x32_bf16 v[54:57], v[94:97], v[14:17], v[54:57]
  ds_read_b64_tr_b16 v[74:75], v110 offset:12832
  ds_read_b64_tr_b16 v[76:77], v110 offset:14112
  s_waitcnt lgkmcnt(8)
  v_mfma_f32_16x16x32_bf16 v[58:61], v[98:101], v[14:17], v[58:61]
  ds_read_b64_tr_b16 v[78:79], v110 offset:12864
  ds_read_b64_tr_b16 v[80:81], v110 offset:14144
  s_waitcnt lgkmcnt(8)
  v_mfma_f32_16x16x32_bf16 v[62:65], v[102:105], v[14:17], v[62:65]
  ds_read_b64_tr_b16 v[82:83], v110 offset:12896
  ds_read_b64_tr_b16 v[84:85], v110 offset:14176
  s_waitcnt lgkmcnt(8)
  v_mfma_f32_16x16x32_bf16 v[66:69], v[106:109], v[14:17], v[66:69]
  ds_read_b64_tr_b16 v[86:87], v110 offset:12928
  ds_read_b64_tr_b16 v[88:89], v110 offset:14208
  s_waitcnt lgkmcnt(8)
  v_mfma_f32_16x16x32_bf16 v[50:53], v[70:73], v[18:21], v[50:53]
  ds_read_b64_tr_b16 v[90:91], v110 offset:19200
  ds_read_b64_tr_b16 v[92:93], v110 offset:20480
  s_waitcnt lgkmcnt(8)
  v_mfma_f32_16x16x32_bf16 v[54:57], v[74:77], v[18:21], v[54:57]
  ds_read_b64_tr_b16 v[94:95], v110 offset:19232
  ds_read_b64_tr_b16 v[96:97], v110 offset:20512
  s_waitcnt lgkmcnt(8)
  v_mfma_f32_16x16x32_bf16 v[58:61], v[78:81], v[18:21], v[58:61]
  ds_read_b64_tr_b16 v[98:99], v110 offset:19264
  ds_read_b64_tr_b16 v[100:101], v110 offset:20544
  s_waitcnt lgkmcnt(8)
  v_mfma_f32_16x16x32_bf16 v[62:65], v[82:85], v[18:21], v[62:65]
  ds_read_b64_tr_b16 v[102:103], v110 offset:19296
  ds_read_b64_tr_b16 v[104:105], v110 offset:20576
  s_waitcnt lgkmcnt(8)
  v_mfma_f32_16x16x32_bf16 v[66:69], v[86:89], v[18:21], v[66:69]
  ds_read_b64_tr_b16 v[106:107], v110 offset:19328
  ds_read_b64_tr_b16 v[108:109], v110 offset:20608
  s_waitcnt lgkmcnt(8)
  v_mfma_f32_16x16x32_bf16 v[50:53], v[90:93], v[22:25], v[50:53]
  ds_read_b64_tr_b16 v[70:71], v110 offset:25600
  ds_read_b64_tr_b16 v[72:73], v110 offset:26880
  s_waitcnt lgkmcnt(8)
  v_mfma_f32_16x16x32_bf16 v[54:57], v[94:97], v[22:25], v[54:57]
  ds_read_b64_tr_b16 v[74:75], v110 offset:25632
  ds_read_b64_tr_b16 v[76:77], v110 offset:26912
  s_waitcnt lgkmcnt(8)
  v_mfma_f32_16x16x32_bf16 v[58:61], v[98:101], v[22:25], v[58:61]
  ds_read_b64_tr_b16 v[78:79], v110 offset:25664
  ds_read_b64_tr_b16 v[80:81], v110 offset:26944
  s_waitcnt lgkmcnt(8)
  v_mfma_f32_16x16x32_bf16 v[62:65], v[102:105], v[22:25], v[62:65]
  ds_read_b64_tr_b16 v[82:83], v110 offset:25696
  ds_read_b64_tr_b16 v[84:85], v110 offset:26976
  s_waitcnt lgkmcnt(8)
  v_mfma_f32_16x16x32_bf16 v[66:69], v[106:109], v[22:25], v[66:69]
  ds_read_b64_tr_b16 v[86:87], v110 offset:25728
  ds_read_b64_tr_b16 v[88:89], v110 offset:27008
  s_waitcnt lgkmcnt(8)
  v_mfma_f32_16x16x32_bf16 v[50:53], v[70:73], v[26:29], v[50:53]
  ds_read_b64_tr_b16 v[90:91], v110 offset:32000
  ds_read_b64_tr_b16 v[92:93], v110 offset:33280
  s_waitcnt lgkmcnt(8)
  v_mfma_f32_16x16x32_bf16 v[54:57], v[74:77], v[26:29], v[54:57]
  ds_read_b64_tr_b16 v[94:95], v110 offset:32032
  ds_read_b64_tr_b16 v[96:97], v110 offset:33312
  s_waitcnt lgkmcnt(8)
  v_mfma_f32_16x16x32_bf16 v[58:61], v[78:81], v[26:29], v[58:61]
  ds_read_b64_tr_b16 v[98:99], v110 offset:32064
  ds_read_b64_tr_b16 v[100:101], v110 offset:33344
  s_waitcnt lgkmcnt(8)
  v_mfma_f32_16x16x32_bf16 v[62:65], v[82:85], v[26:29], v[62:65]
  ds_read_b64_tr_b16 v[102:103], v110 offset:32096
  ds_read_b64_tr_b16 v[104:105], v110 offset:33376
  s_waitcnt lgkmcnt(8)
  v_mfma_f32_16x16x32_bf16 v[66:69], v[86:89], v[26:29], v[66:69]
  ds_read_b64_tr_b16 v[106:107], v110 offset:32128
  ds_read_b64_tr_b16 v[108:109], v110 offset:33408
  s_waitcnt lgkmcnt(8)
  v_mfma_f32_16x16x32_bf16 v[50:53], v[90:93], v[30:33], v[50:53]
  ds_read_b64_tr_b16 v[70:71], v110 offset:38400
  ds_read_b64_tr_b16 v[72:73], v110 offset:39680
  s_waitcnt lgkmcnt(8)
  v_mfma_f32_16x16x32_bf16 v[54:57], v[94:97], v[30:33], v[54:57]
  ds_read_b64_tr_b16 v[74:75], v110 offset:38432
  ds_read_b64_tr_b16 v[76:77], v110 offset:39712
  s_waitcnt lgkmcnt(8)
  v_mfma_f32_16x16x32_bf16 v[58:61], v[98:101], v[30:33], v[58:61]
  ds_read_b64_tr_b16 v[78:79], v110 offset:38464
  ds_read_b64_tr_b16 v[80:81], v110 offset:39744
  s_waitcnt lgkmcnt(8)
  v_mfma_f32_16x16x32_bf16 v[62:65], v[102:105], v[30:33], v[62:65]
  ds_read_b64_tr_b16 v[82:83], v110 offset:38496
  ds_read_b64_tr_b16 v[84:85], v110 offset:39776
  s_waitcnt lgkmcnt(8)
  v_mfma_f32_16x16x32_bf16 v[66:69], v[106:109], v[30:33], v[66:69]
  ds_read_b64_tr_b16 v[86:87], v110 offset:38528
  ds_read_b64_tr_b16 v[88:89], v110 offset:39808
  s_waitcnt lgkmcnt(8)
  v_mfma_f32_16x16x32_bf16 v[50:53], v[70:73], v[34:37], v[50:53]
  ds_read_b64_tr_b16 v[90:91], v110 offset:44800
  ds_read_b64_tr_b16 v[92:93], v110 offset:46080
  s_waitcnt lgkmcnt(8)
  v_mfma_f32_16x16x32_bf16 v[54:57], v[74:77], v[34:37], v[54:57]
  ds_read_b64_tr_b16 v[94:95], v110 offset:44832
  ds_read_b64_tr_b16 v[96:97], v110 offset:46112
  s_waitcnt lgkmcnt(8)
  v_mfma_f32_16x16x32_bf16 v[58:61], v[78:81], v[34:37], v[58:61]
  ds_read_b64_tr_b16 v[98:99], v110 offset:44864
  ds_read_b64_tr_b16 v[100:101], v110 offset:46144
  s_waitcnt lgkmcnt(8)
  v_mfma_f32_16x16x32_bf16 v[62:65], v[82:85], v[34:37], v[62:65]
  ds_read_b64_tr_b16 v[102:103], v110 offset:44896
  ds_read_b64_tr_b16 v[104:105], v110 offset:46176
  s_waitcnt lgkmcnt(8)
  v_mfma_f32_16x16x32_bf16 v[66:69], v[86:89], v[34:37], v[66:69]
  ds_read_b64_tr_b16 v[106:107], v110 offset:44928
  ds_read_b64_tr_b16 v[108:109], v110 offset:46208
  s_waitcnt lgkmcnt(8)
  v_mfma_f32_16x16x32_bf16 v[50:53], v[90:93], v[38:41], v[50:53]
  ds_read_b64_tr_b16 v[70:71], v111 offset:0
  ds_read_b64_tr_b16 v[72:73], v111 offset:3200
  s_waitcnt lgkmcnt(8)
  v_mfma_f32_16x16x32_bf16 v[54:57], v[94:97], v[38:41], v[54:57]
  ds_read_b64_tr_b16 v[74:75], v111 offset:32
  ds_read_b64_tr_b16 v[76:77], v111 offset:3232
  s_waitcnt lgkmcnt(8)
  v_mfma_f32_16x16x32_bf16 v[58:61], v[98:101], v[38:41], v[58:61]
  ds_read_b64_tr_b16 v[78:79], v111 offset:64
  ds_read_b64_tr_b16 v[80:81], v111 offset:3264
  s_waitcnt lgkmcnt(8)
  v_mfma_f32_16x16x32_bf16 v[62:65], v[102:105], v[38:41], v[62:65]
  ds_read_b64_tr_b16 v[82:83], v111 offset:96
  ds_read_b64_tr_b16 v[84:85], v111 offset:3296
  s_waitcnt lgkmcnt(8)
  v_mfma_f32_16x16x32_bf16 v[66:69], v[106:109], v[38:41], v[66:69]
  ds_read_b64_tr_b16 v[86:87], v111 offset:128
  ds_read_b64_tr_b16 v[88:89], v111 offset:3328
  s_waitcnt lgkmcnt(8)
  v_mfma_f32_16x16x32_bf16 v[50:53], v[70:73], v[42:45], v[50:53]
  ds_read_b64_tr_b16 v[90:91], v111 offset:25600
  ds_read_b64_tr_b16 v[92:93], v111 offset:28800
  s_waitcnt lgkmcnt(8)
  v_mfma_f32_16x16x32_bf16 v[54:57], v[74:77], v[42:45], v[54:57]
  ds_read_b64_tr_b16 v[94:95], v111 offset:25632
  ds_read_b64_tr_b16 v[96:97], v111 offset:28832
  s_waitcnt lgkmcnt(8)
  v_mfma_f32_16x16x32_bf16 v[58:61], v[78:81], v[42:45], v[58:61]
  ds_read_b64_tr_b16 v[98:99], v111 offset:25664
  ds_read_b64_tr_b16 v[100:101], v111 offset:28864
  s_waitcnt lgkmcnt(8)
  v_mfma_f32_16x16x32_bf16 v[62:65], v[82:85], v[42:45], v[62:65]
  ds_read_b64_tr_b16 v[102:103], v111 offset:25696
  ds_read_b64_tr_b16 v[104:105], v111 offset:28896
  s_waitcnt lgkmcnt(8)
  v_mfma_f32_16x16x32_bf16 v[66:69], v[86:89], v[42:45], v[66:69]
  ds_read_b64_tr_b16 v[106:107], v111 offset:25728
  ds_read_b64_tr_b16 v[108:109], v111 offset:28928
  s_waitcnt lgkmcnt(8)
  v_mfma_f32_16x16x32_bf16 v[50:53], v[90:93], v[46:49], v[50:53]
  s_waitcnt lgkmcnt(6)
  v_mfma_f32_16x16x32_bf16 v[54:57], v[94:97], v[46:49], v[54:57]
  s_waitcnt lgkmcnt(4)
  v_mfma_f32_16x16x32_bf16 v[58:61], v[98:101], v[46:49], v[58:61]
  s_waitcnt lgkmcnt(2)
  v_mfma_f32_16x16x32_bf16 v[62:65], v[102:105], v[46:49], v[62:65]
  s_waitcnt lgkmcnt(0)
  v_mfma_f32_16x16x32_bf16 v[66:69], v[106:109], v[46:49], v[66:69]
  ds_write_b128 v114, v[50:53] offset:0
  s_nop 0
  ds_write_b128 v114, v[54:57] offset:64
  s_nop 0
  ds_write_b128 v114, v[58:61] offset:128
  s_nop 0
  ds_write_b128 v114, v[62:65] offset:192
  s_nop 0
  ds_write_b128 v114, v[66:69] offset:256
  s_waitcnt lgkmcnt(0)
  s_barrier
  ds_read_b64 v[0:1], v113 offset:0
  ds_read_b64 v[2:3], v113 offset:8
  ds_read_b64 v[4:5], v113 offset:16
  ds_read_b64 v[6:7], v113 offset:24
  ds_read_b64 v[8:9], v113 offset:32
  ds_read_b64 v[10:11], v113 offset:21504
  ds_read_b64 v[12:13], v113 offset:21512
  ds_read_b64 v[14:15], v113 offset:21520
  ds_read_b64 v[16:17], v113 offset:21528
  ds_read_b64 v[18:19], v113 offset:21536
  s_lshl_b32 s37, s24, 13
  s_add_u32 s37, s37, 15728640
  s_lshl_b32 s38, s25, 10
  s_add_u32 s38, s38, s37
  s_waitcnt lgkmcnt(0)
  v_add_f32 v0, v0, v10
  v_add_f32 v1, v1, v11
  v_add_f32 v2, v2, v12
  v_add_f32 v3, v3, v13
  v_add_f32 v4, v4, v14
  v_add_f32 v5, v5, v15
  v_add_f32 v6, v6, v16
  v_add_f32 v7, v7, v17
  v_add_f32 v8, v8, v18
  v_add_f32 v9, v9, v19
  v_cvt_pk_bf16_f32 v10, v0, v1
  v_lshlrev_b32 v20, 16, v178
  v_and_b32 v21, 0xffff0000, v178
  v_lshlrev_b32 v0, 16, v10
  v_and_b32 v1, 0xffff0000, v10
  v_add_f32 v0, v0, v20
  v_add_f32 v1, v1, v21
  v_cvt_pk_bf16_f32 v24, v0, v1
  v_lshlrev_b32 v0, 16, v24
  v_and_b32 v1, 0xffff0000, v24
  v_add_f32 v30, v0, v1
  v_dot2_f32_bf16 v31, v24, v24, 0
  v_dot2_f32_bf16 v32, v24, v184, 0
  v_cvt_pk_bf16_f32 v11, v2, v3
  v_lshlrev_b32 v20, 16, v179
  v_and_b32 v21, 0xffff0000, v179
  v_lshlrev_b32 v2, 16, v11
  v_and_b32 v3, 0xffff0000, v11
  v_add_f32 v2, v2, v20
  v_add_f32 v3, v3, v21
  v_cvt_pk_bf16_f32 v25, v2, v3
  v_lshlrev_b32 v2, 16, v25
  v_and_b32 v3, 0xffff0000, v25
  v_add_f32 v22, v2, v3
  v_dot2c_f32_bf16 v31, v25, v25
  v_dot2c_f32_bf16 v32, v25, v185
  v_add_f32 v30, v30, v22
  v_cvt_pk_bf16_f32 v12, v4, v5
  v_lshlrev_b32 v20, 16, v180
  v_and_b32 v21, 0xffff0000, v180
  v_lshlrev_b32 v4, 16, v12
  v_and_b32 v5, 0xffff0000, v12
  v_add_f32 v4, v4, v20
  v_add_f32 v5, v5, v21
  v_cvt_pk_bf16_f32 v26, v4, v5
  v_lshlrev_b32 v4, 16, v26
  v_and_b32 v5, 0xffff0000, v26
  v_add_f32 v22, v4, v5
  v_dot2c_f32_bf16 v31, v26, v26
  v_dot2c_f32_bf16 v32, v26, v186
  v_add_f32 v30, v30, v22
  v_cvt_pk_bf16_f32 v13, v6, v7
  v_lshlrev_b32 v20, 16, v181
  v_and_b32 v21, 0xffff0000, v181
  v_lshlrev_b32 v6, 16, v13
  v_and_b32 v7, 0xffff0000, v13
  v_add_f32 v6, v6, v20
  v_add_f32 v7, v7, v21
  v_cvt_pk_bf16_f32 v27, v6, v7
  v_lshlrev_b32 v6, 16, v27
  v_and_b32 v7, 0xffff0000, v27
  v_add_f32 v22, v6, v7
  v_dot2c_f32_bf16 v31, v27, v27
  v_dot2c_f32_bf16 v32, v27, v187
  v_add_f32 v30, v30, v22
  v_cvt_pk_bf16_f32 v14, v8, v9
  v_lshlrev_b32 v20, 16, v182
  v_and_b32 v21, 0xffff0000, v182
  v_lshlrev_b32 v8, 16, v14
  v_and_b32 v9, 0xffff0000, v14
  v_add_f32 v8, v8, v20
  v_add_f32 v9, v9, v21
  v_cvt_pk_bf16_f32 v28, v8, v9
  v_lshlrev_b32 v8, 16, v28
  v_and_b32 v9, 0xffff0000, v28
  v_add_f32 v22, v8, v9
  v_dot2c_f32_bf16 v31, v28, v28
  v_dot2c_f32_bf16 v32, v28, v188
  v_add_f32 v30, v30, v22
  v_mov_b32 v33, 0
  s_nop 0
  v_add_f32_dpp v30, v30, v30 quad_perm:[1,0,3,2] row_mask:0xf bank_mask:0xf
  v_add_f32_dpp v31, v31, v31 quad_perm:[1,0,3,2] row_mask:0xf bank_mask:0xf
  v_add_f32_dpp v32, v32, v32 quad_perm:[1,0,3,2] row_mask:0xf bank_mask:0xf
  v_add_f32_dpp v30, v30, v30 quad_perm:[2,3,0,1] row_mask:0xf bank_mask:0xf
  v_add_f32_dpp v31, v31, v31 quad_perm:[2,3,0,1] row_mask:0xf bank_mask:0xf
  v_add_f32_dpp v32, v32, v32 quad_perm:[2,3,0,1] row_mask:0xf bank_mask:0xf
  v_add_f32_dpp v30, v30, v30 row_half_mirror row_mask:0xf bank_mask:0xf
  v_add_f32_dpp v31, v31, v31 row_half_mirror row_mask:0xf bank_mask:0xf
  v_add_f32_dpp v32, v32, v32 row_half_mirror row_mask:0xf bank_mask:0xf
  v_min_u32 v30, -2, v30
  v_min_u32 v31, -2, v31
  v_min_u32 v32, -2, v32
  s_cmp_eq_u32 s101, 1
  s_cbranch_scc1 sequential_preLN__mha_block__moe_arch_mod__prompt_kernel_d1107
  s_mov_b32 exec_lo, 0x01010101
  s_mov_b32 exec_hi, 0x01010101
  buffer_store_dwordx4 v[30:33], v115, s[20:23], s38 offen
  s_mov_b64 exec, -1
  s_branch sequential_preLN__mha_block__moe_arch_mod__prompt_kernel_d2108
sequential_preLN__mha_block__moe_arch_mod__prompt_kernel_d1107:
  s_mov_b32 exec_lo, 0x01010101
  s_mov_b32 exec_hi, 0x01010101
  buffer_store_dwordx4 v[30:33], v115, s[20:23], s38 offen sc1
  s_mov_b64 exec, -1
sequential_preLN__mha_block__moe_arch_mod__prompt_kernel_d2108:
sequential_preLN__mha_block__moe_arch_mod__prompt_kernel_poll109:
  buffer_load_dwordx3 v[34:36], v116, s[20:23], s37 offen sc1
  s_waitcnt vmcnt(0)
  v_max3_u32 v37, v34, v35, v36
  v_cmp_eq_u32 vcc, -1, v37
  s_nop 4
  s_cbranch_vccz sequential_preLN__mha_block__moe_arch_mod__prompt_kernel_ok110
  s_sub_u32 s75, s75, 1
  s_cbranch_scc1 sequential_preLN__mha_block__moe_arch_mod__prompt_kernel_end1
  s_branch sequential_preLN__mha_block__moe_arch_mod__prompt_kernel_poll109
sequential_preLN__mha_block__moe_arch_mod__prompt_kernel_ok110:
  v_add_f32_dpp v34, v34, v34 quad_perm:[1,0,3,2] row_mask:0xf bank_mask:0xf
  v_add_f32_dpp v35, v35, v35 quad_perm:[1,0,3,2] row_mask:0xf bank_mask:0xf
  v_add_f32_dpp v36, v36, v36 quad_perm:[1,0,3,2] row_mask:0xf bank_mask:0xf
  v_add_f32_dpp v34, v34, v34 quad_perm:[2,3,0,1] row_mask:0xf bank_mask:0xf
  v_add_f32_dpp v35, v35, v35 quad_perm:[2,3,0,1] row_mask:0xf bank_mask:0xf
  v_add_f32_dpp v36, v36, v36 quad_perm:[2,3,0,1] row_mask:0xf bank_mask:0xf
  v_add_f32_dpp v34, v34, v34 row_half_mirror row_mask:0xf bank_mask:0xf
  v_add_f32_dpp v35, v35, v35 row_half_mirror row_mask:0xf bank_mask:0xf
  v_add_f32_dpp v36, v36, v36 row_half_mirror row_mask:0xf bank_mask:0xf
  s_mov_b32 s3, 0x3acccccd
  v_mul_f32 v34, s3, v34
  v_mul_f32 v35, s3, v35
  v_fma_f32 v35, -v34, v34, v35
  v_max_f32 v35, 0, v35
  v_cvt_pk_bf16_f32 v35, v35, v35
  v_and_b32 v35, 0xffff0000, v35
  v_add_f32 v35, 0x3727c5ac, v35
  v_cvt_pk_bf16_f32 v35, v35, v35
  v_and_b32 v35, 0xffff0000, v35
  v_sqrt_f32 v35, v35
  v_cvt_pk_bf16_f32 v34, v34, v34
  v_and_b32 v34, 0xffff0000, v34
  v_cvt_pk_bf16_f32 v35, v35, v35
  v_and_b32 v35, 0xffff0000, v35
  v_rcp_f32 v35, v35
  v_fma_f32 v36, -v34, s57, v36
  s_lshl_b32 s39, s24, 6
  v_lshrrev_b32 v38, 3, v159
  v_add_u32 v38, s39, v38
  v_mul_f32 v36, v36, v35
  v_sub_u32 v39, 0x7ff, v38
  v_cvt_pk_bf16_f32 v36, v36, v36
  v_ashrrev_i32 v37, 31, v36
  v_or_b32 v37, 0x80000000, v37
  v_xor_b32 v36, v36, v37
  v_and_b32 v36, 0xffff0000, v36
  v_or_b32 v36, v36, v39
  v_lshrrev_b32 v20, 1, v159
  s_mov_b32 exec_lo, 0x01010101
  s_mov_b32 exec_hi, 0x01010101
  ds_write_b32 v20, v36 offset:1024
  s_mov_b64 exec, -1
  v_lshlrev_b32 v20, 2, v155
  v_sub_f32 v22, v0, v34
  v_sub_f32 v21, v1, v34
  v_cvt_pk_bf16_f32 v21, v22, v21
  v_lshlrev_b32 v22, 16, v21
  v_and_b32 v21, 0xffff0000, v21
  v_mul_f32 v22, v22, v35
  v_mul_f32 v21, v21, v35
  v_cvt_pk_bf16_f32 v40, v22, v21
  v_sub_f32 v22, v2, v34
  v_sub_f32 v21, v3, v34
  v_cvt_pk_bf16_f32 v21, v22, v21
  v_lshlrev_b32 v22, 16, v21
  v_and_b32 v21, 0xffff0000, v21
  v_mul_f32 v22, v22, v35
  v_mul_f32 v21, v21, v35
  v_cvt_pk_bf16_f32 v41, v22, v21
  s_waitcnt lgkmcnt(0)
  s_barrier
  ds_read_b32 v23, v20 offset:1024
  v_sub_f32 v22, v4, v34
  v_sub_f32 v21, v5, v34
  v_cvt_pk_bf16_f32 v21, v22, v21
  v_lshlrev_b32 v22, 16, v21
  v_and_b32 v21, 0xffff0000, v21
  v_mul_f32 v22, v22, v35
  v_mul_f32 v21, v21, v35
  v_cvt_pk_bf16_f32 v42, v22, v21
  v_sub_f32 v22, v6, v34
  v_sub_f32 v21, v7, v34
  v_cvt_pk_bf16_f32 v21, v22, v21
  v_lshlrev_b32 v22, 16, v21
  v_and_b32 v21, 0xffff0000, v21
  v_mul_f32 v22, v22, v35
  v_mul_f32 v21, v21, v35
  v_cvt_pk_bf16_f32 v43, v22, v21
  v_sub_f32 v22, v8, v34
  v_sub_f32 v21, v9, v34
  v_cvt_pk_bf16_f32 v21, v22, v21
  v_lshlrev_b32 v22, 16, v21
  v_and_b32 v21, 0xffff0000, v21
  v_mul_f32 v22, v22, v35
  v_mul_f32 v21, v21, v35
  v_cvt_pk_bf16_f32 v44, v22, v21
  s_waitcnt lgkmcnt(0)
  v_max_u32_dpp v23, v23, v23 quad_perm:[1,0,3,2] row_mask:0xf bank_mask:0xf
  s_nop 1
  v_max_u32_dpp v23, v23, v23 quad_perm:[2,3,0,1] row_mask:0xf bank_mask:0xf
  s_nop 1
  v_max_u32_dpp v23, v23, v23 row_half_mirror row_mask:0xf bank_mask:0xf
  s_nop 1
  v_max_u32_dpp v23, v23, v23 row_mirror row_mask:0xf bank_mask:0xf
  s_nop 0
  v_readlane_b32 s60, v23, 0
  v_readlane_b32 s61, v23, 16
  v_readlane_b32 s62, v23, 32
  v_readlane_b32 s63, v23, 48
  s_lshl_b32 s64, s25, 8
  s_add_u32 s64, s64, 15990784
  s_lshl_b32 s3, s24, 2
  s_add_u32 s3, s3, s64
  s_max_u32 s60, s60, s61
  s_max_u32 s62, s62, s63
  s_max_u32 s60, s60, s62
  v_mov_b32 v23, s60
  s_cmp_eq_u32 s26, 0
  s_cselect_b64 exec, 1, 0
  s_cmp_eq_u32 s71, 0
  s_cbranch_scc1 sequential_preLN__mha_block__moe_arch_mod__prompt_kernel_q1111
  buffer_store_dword v23, off, s[20:23], s3 sc1
  s_branch sequential_preLN__mha_block__moe_arch_mod__prompt_kernel_q2112
sequential_preLN__mha_block__moe_arch_mod__prompt_kernel_q1111:
  buffer_store_dword v23, off, s[20:23], s3 offset:2048
sequential_preLN__mha_block__moe_arch_mod__prompt_kernel_q2112:
  s_mov_b64 exec, -1
  v_min_u32 v24, -2, v24
  v_min_u32 v40, -2, v40
  v_min_u32 v25, -2, v25
  v_min_u32 v41, -2, v41
  v_min_u32 v26, -2, v26
  v_min_u32 v42, -2, v42
  v_min_u32 v27, -2, v27
  v_min_u32 v43, -2, v43
  v_min_u32 v28, -2, v28
  v_min_u32 v44, -2, v44
  v_cmp_eq_u32 vcc, s60, v36
  s_mul_i32 s39, s24, 2560
  s_add_u32 s39, s39, s42
  s_add_u32 s39, s39, 15994880
  s_nop 1
  s_cbranch_vccz sequential_preLN__mha_block__moe_arch_mod__prompt_kernel_nc113
  s_mov_b64 exec, vcc
  buffer_store_dwordx4 v[40:43], v229, s[20:23], s39 offen sc1
  buffer_store_dword v44, v229, s[20:23], s39 offen offset:16 sc1
  buffer_store_dwordx4 v[24:27], v229, s[20:23], s39 offen offset:1280 sc1
  buffer_store_dword v28, v229, s[20:23], s39 offen offset:1296 sc1
  s_mov_b64 exec, -1
sequential_preLN__mha_block__moe_arch_mod__prompt_kernel_nc113:
  v_lshlrev_b32 v20, 16, v40
  v_and_b32 v21, 0xffff0000, v40
  v_add_f32 v20, v20, v0
  v_add_f32 v21, v21, v1
  v_cvt_pk_bf16_f32 v46, v20, v21
  v_lshlrev_b32 v20, 16, v41
  v_and_b32 v21, 0xffff0000, v41
  v_add_f32 v20, v20, v2
  v_add_f32 v21, v21, v3
  v_cvt_pk_bf16_f32 v47, v20, v21
  v_lshlrev_b32 v20, 16, v42
  v_and_b32 v21, 0xffff0000, v42
  v_add_f32 v20, v20, v4
  v_add_f32 v21, v21, v5
  v_cvt_pk_bf16_f32 v48, v20, v21
  v_lshlrev_b32 v20, 16, v43
  v_and_b32 v21, 0xffff0000, v43
  v_add_f32 v20, v20, v6
  v_add_f32 v21, v21, v7
  v_cvt_pk_bf16_f32 v49, v20, v21
  v_lshlrev_b32 v20, 16, v44
  v_and_b32 v21, 0xffff0000, v44
  v_add_f32 v20, v20, v8
  v_add_f32 v21, v21, v9
  v_cvt_pk_bf16_f32 v50, v20, v21
  s_mov_b64 s[10:11], -1
  s_cmp_eq_u32 s26, 0
  s_cbranch_scc1 sequential_preLN__mha_block__moe_arch_mod__prompt_kernel_w1115
  s_mov_b64 s[10:11], vcc
  s_not_b64 exec, vcc
  buffer_store_dwordx4 v[46:49], v228, s[48:51], s43 offen
  buffer_store_dword v50, v228, s[48:51], s43 offen offset:16
  s_mov_b64 exec, -1
  s_branch sequential_preLN__mha_block__moe_arch_mod__prompt_kernel_w0d114
sequential_preLN__mha_block__moe_arch_mod__prompt_kernel_w1115:
  buffer_load_dword v176, v153, s[20:23], s35 offen sc1
  s_waitcnt vmcnt(0)
sequential_preLN__mha_block__moe_arch_mod__prompt_kernel_lk117:
  v_cndmask_b32 v176, v176, v23, s[68:69]
  v_max3_u32 v20, v164, v165, v166
  v_max3_u32 v21, v167, v168, v169
  v_max3_u32 v22, v170, v171, v172
  v_cmp_eq_u32 s[8:9], -1, v176
  v_max3_u32 v20, v20, v173, v174
  v_max3_u32 v21, v21, v22, v175
  v_max_u32 v20, v20, v21
  v_cmp_eq_u32 vcc, -1, v20
  v_add_u32 v176, 1, v176
  s_nop 1
  v_max_u32_dpp v176, v176, v176 quad_perm:[1,0,3,2] row_mask:0xf bank_mask:0xf
  s_nop 1
  v_max_u32_dpp v176, v176, v176 quad_perm:[2,3,0,1] row_mask:0xf bank_mask:0xf
  s_nop 1
  v_max_u32_dpp v176, v176, v176 row_half_mirror row_mask:0xf bank_mask:0xf
  s_nop 1
  v_max_u32_dpp v176, v176, v176 row_mirror row_mask:0xf bank_mask:0xf
  s_nop 0
  v_readlane_b32 s60, v176, 0
  v_readlane_b32 s61, v176, 16
  s_nop 0
  s_max_u32 s60, s60, s61
  s_sub_u32 s60, s60, 1
  s_and_b32 s61, s60, 0x7ff
  s_sub_u32 s61, 0x7ff, s61
  s_lshr_b32 s62, s61, 6
  s_mul_i32 s62, s62, 2560
  s_add_u32 s62, s62, 15994880
  s_cbranch_vccnz sequential_preLN__mha_block__moe_arch_mod__prompt_kernel_ag119
  s_cmp_lg_u32 s62, s65
  s_cbranch_scc1 sequential_preLN__mha_block__moe_arch_mod__prompt_kernel_ag119
  s_cmp_eq_u64 s[8:9], 0
  s_cbranch_scc1 sequential_preLN__mha_block__moe_arch_mod__prompt_kernel_kd118
  buffer_load_dword v176, v153, s[20:23], s35 offen sc1
  s_branch sequential_preLN__mha_block__moe_arch_mod__prompt_kernel_wt120
sequential_preLN__mha_block__moe_arch_mod__prompt_kernel_ag119:
  buffer_load_dword v176, v153, s[20:23], s35 offen sc1
  s_bcnt1_i32_b64 s3, s[8:9]
  s_cmp_gt_u32 s3, 6
  s_cbranch_scc1 sequential_preLN__mha_block__moe_arch_mod__prompt_kernel_wt120
  s_mov_b32 s65, s62
  buffer_load_dwordx4 v[164:167], v158, s[20:23], s65 offen sc1
  buffer_load_dwordx4 v[168:171], v150, s[20:23], s65 offen sc1
  buffer_load_dwordx4 v[172:175], v151, s[20:23], s65 offen sc1
sequential_preLN__mha_block__moe_arch_mod__prompt_kernel_wt120:
  s_sub_u32 s75, s75, 1
  s_cbranch_scc1 sequential_preLN__mha_block__moe_arch_mod__prompt_kernel_end1
  s_waitcnt vmcnt(0)
  s_branch sequential_preLN__mha_block__moe_arch_mod__prompt_kernel_lk117
sequential_preLN__mha_block__moe_arch_mod__prompt_kernel_kd118:
  ds_write_b128 v158, v[164:167] offset:2048
  ds_write_b128 v148, v[168:171] offset:2048
  ds_write_b128 v149, v[172:175] offset:2048
  v_mov_b32 v23, s60
  ds_write_b32 v177, v23 offset:1536
  s_waitcnt lgkmcnt(0)
sequential_preLN__mha_block__moe_arch_mod__prompt_kernel_w0d114:
  s_barrier
  v_lshlrev_b32 v20, 2, v159
  v_mov_b32 v23, 0
  ds_read_b32 v21, v20 offset:2048
  ds_read_b32 v23, v23 offset:1536
  s_cmp_ge_u32 s2, 216
  s_cbranch_scc1 sequential_preLN__mha_block__moe_arch_mod__prompt_kernel_dn2121
  s_cmp_ge_u32 s26, 5
  s_cbranch_scc1 sequential_preLN__mha_block__moe_arch_mod__prompt_kernel_bar122
  s_waitcnt lgkmcnt(1)
  v_dot2_f32_bf16 v60, v190, v21, 0
  v_dot2_f32_bf16 v61, v191, v21, 0
  v_dot2_f32_bf16 v62, v192, v21, 0
  v_dot2_f32_bf16 v63, v193, v21, 0
  v_dot2_f32_bf16 v64, v194, v21, 0
  v_dot2_f32_bf16 v65, v195, v21, 0
  v_dot2_f32_bf16 v66, v196, v21, 0
  v_dot2_f32_bf16 v67, v197, v21, 0
  v_dot2_f32_bf16 v68, v198, v21, 0
  v_dot2_f32_bf16 v69, v199, v21, 0
  v_dot2_f32_bf16 v70, v200, v21, 0
  v_dot2_f32_bf16 v71, v201, v21, 0
  v_dot2_f32_bf16 v72, v202, v21, 0
  v_dot2_f32_bf16 v73, v203, v21, 0
  v_dot2_f32_bf16 v74, v204, v21, 0
  v_dot2_f32_bf16 v75, v205, v21, 0
  v_permlane32_swap_b32 v60, v68
  v_permlane32_swap_b32 v61, v69
  v_permlane32_swap_b32 v62, v70
  v_permlane32_swap_b32 v63, v71
  v_permlane32_swap_b32 v64, v72
  v_permlane32_swap_b32 v65, v73
  v_permlane32_swap_b32 v66, v74
  v_permlane32_swap_b32 v67, v75
  v_add_f32 v60, v60, v68
  v_add_f32 v61, v61, v69
  v_add_f32 v62, v62, v70
  v_add_f32 v63, v63, v71
  v_add_f32 v64, v64, v72
  v_add_f32 v65, v65, v73
  v_add_f32 v66, v66, v74
  v_add_f32 v67, v67, v75
  v_permlane16_swap_b32 v60, v64
  v_permlane16_swap_b32 v61, v65
  v_permlane16_swap_b32 v62, v66
  v_permlane16_swap_b32 v63, v67
  v_add_f32 v60, v60, v64
  v_add_f32 v61, v61, v65
  v_add_f32 v62, v62, v66
  v_add_f32 v63, v63, v67
  v_add_f32_dpp v60, v60, v60 row_ror:8 row_mask:0xf bank_mask:0x3
  v_add_f32_dpp v61, v61, v61 row_ror:8 row_mask:0xf bank_mask:0x3
  s_nop 0
  v_add_f32_dpp v60, v62, v62 row_ror:8 row_mask:0xf bank_mask:0xc
  v_add_f32_dpp v61, v63, v63 row_ror:8 row_mask:0xf bank_mask:0xc
  s_nop 0
  v_add_f32_dpp v60, v60, v60 row_half_mirror row_mask:0xf bank_mask:0x5
  s_nop 1
  v_add_f32_dpp v60, v61, v61 row_half_mirror row_mask:0xf bank_mask:0xa
  s_nop 1
  v_add_f32_dpp v60, v60, v60 quad_perm:[1,0,3,2] row_mask:0xf bank_mask:0xf
  s_nop 1
  v_add_f32_dpp v60, v60, v60 quad_perm:[2,3,0,1] row_mask:0xf bank_mask:0xf
  v_lshlrev_b32 v20, 3, v155
  s_lshl_b32 s3, s26, 2
  v_add_u32 v20, s3, v20
  s_mov_b32 exec_lo, 0x11111111
  s_mov_b32 exec_hi, 0x11111111
  ds_write_b32 v20, v60
  s_mov_b64 exec, -1
sequential_preLN__mha_block__moe_arch_mod__prompt_kernel_bar122:
  s_waitcnt lgkmcnt(0)
  s_barrier
  s_cmp_ge_u32 s26, 5
  s_cbranch_scc1 sequential_preLN__mha_block__moe_arch_mod__prompt_kernel_fin123
  v_lshlrev_b32 v20, 5, v155
  s_mov_b64 exec, 0xff
  ds_read_b128 v[60:63], v20
  ds_read_b32 v64, v20 offset:16
  ds_read_b128 v[68:71], v20 offset:256
  ds_read_b32 v72, v20 offset:272
  s_lshl_b32 s3, s74, 2
  s_add_u32 s3, s3, 16076800
  s_waitcnt lgkmcnt(0)
  v_add_f32 v60, v60, v61
  v_add_f32 v62, v62, v63
  v_add_f32 v60, v60, v64
  v_add_f32 v60, v60, v62
  v_cvt_pk_bf16_f32 v60, v60, v60
  v_and_b32 v60, 0xffff0000, v60
  v_add_f32 v68, v68, v69
  v_add_f32 v70, v70, v71
  v_add_f32 v68, v68, v72
  v_add_f32 v68, v68, v70
  v_cvt_pk_bf16_f32 v68, v68, v68
  v_and_b32 v68, 0xffff0000, v68
  v_mul_f32 v61, 0xbfb8aa3b, v60
  v_exp_f32 v61, v61
  s_nop 0
  v_add_f32 v61, 1.0, v61
  v_rcp_f32 v61, v61
  s_nop 0
  v_mul_f32 v60, v60, v61
  v_cvt_pk_bf16_f32 v60, v60, v60
  v_and_b32 v60, 0xffff0000, v60
  v_mul_f32 v60, v60, v68
  s_nop 1
  v_mov_b32_dpp v61, v60 quad_perm:[1,0,3,2] row_mask:0xf bank_mask:0xf
  v_cvt_pk_bf16_f32 v60, v60, v61
  s_mov_b64 exec, -1
  v_readlane_b32 s4, v60, 0
  v_readlane_b32 s5, v60, 2
  v_readlane_b32 s6, v60, 4
  v_readlane_b32 s7, v60, 6
  v_dot2_f32_bf16 v62, v214, s4, 0
  v_dot2_f32_bf16 v63, v215, s4, 0
  v_dot2_f32_bf16 v64, v216, s5, 0
  v_dot2_f32_bf16 v65, v217, s5, 0
  v_dot2_f32_bf16 v62, v218, s6, v62
  v_dot2_f32_bf16 v63, v219, s6, v63
  v_dot2_f32_bf16 v64, v220, s7, v64
  v_dot2_f32_bf16 v65, v221, s7, v65
  s_nop 1
  v_add_f32 v62, v62, v64
  v_add_f32 v63, v63, v65
  v_min_u32 v62, -2, v62
  v_min_u32 v63, -2, v63
  s_andn2_b64 exec, -1, s[72:73]
  buffer_store_dwordx2 v[62:63], v206, s[20:23], s54 offen sc1
  s_mov_b64 exec, s[72:73]
  buffer_store_dwordx2 v[62:63], v206, s[20:23], s54 offen
  s_mov_b64 exec, -1
sequential_preLN__mha_block__moe_arch_mod__prompt_kernel_fin123:
  v_readfirstlane_b32 s60, v23
  s_nop 0
  s_and_b32 s61, s60, 0x7ff
  s_sub_u32 s61, 0x7ff, s61
  v_cmp_ne_u32 s[66:67], s61, v38
  s_nop 0
  s_and_b64 exec, s[66:67], s[10:11]
  buffer_store_dwordx4 v[46:49], v228, s[48:51], s43 offen
  buffer_store_dword v50, v228, s[48:51], s43 offen offset:16
  s_mov_b64 exec, -1
  s_endpgm
sequential_preLN__mha_block__moe_arch_mod__prompt_kernel_dn2121:
  v_lshlrev_b32 v20, 1, v155
  v_add_u32 v20, s74, v20
  ds_read_u16 v24, v20 offset:2048
  ds_read_u16 v25, v20 offset:3328
  s_waitcnt lgkmcnt(0)
  v_readfirstlane_b32 s60, v23
  s_nop 0
  s_and_b32 s61, s60, 0x7ff
  s_sub_u32 s61, 0x7ff, s61
  v_cmp_ne_u32 s[66:67], s61, v38
  s_nop 0
  s_and_b64 exec, s[66:67], s[10:11]
  buffer_store_dwordx4 v[46:49], v228, s[48:51], s43 offen
  buffer_store_dword v50, v228, s[48:51], s43 offen offset:16
  s_mov_b64 exec, -1
  v_lshlrev_b32 v24, 16, v24
  v_lshlrev_b32 v25, 16, v25
  s_and_b32 s60, s60, 0xffff0000
  s_ashr_i32 s3, s60, 31
  s_not_b32 s3, s3
  s_or_b32 s3, s3, 0x80000000
  s_xor_b32 s60, s60, s3
  s_and_b32 s60, s60, 0xffff0000
  v_mov_b32 v26, 0xbfb8aa3b
  v_mul_f32 v26, s60, v26
  v_exp_f32 v26, v26
  s_nop 0
  v_add_f32 v26, 1.0, v26
  v_rcp_f32 v26, v26
  s_nop 0
  v_cvt_pk_bf16_f32 v26, v26, v26
  v_and_b32 v26, 0xffff0000, v26
  v_lshlrev_b32 v20, 4, v159
  v_add_u32 v21, 8192, v20
  v_mov_b32 v27, 0x80000000
  v_lshrrev_b32 v22, 6, v20
  v_mul_u32_u24 v23, 2341, v22
  v_lshrrev_b32 v23, 16, v23
  v_mul_u32_u24 v23, 28, v23
  v_sub_u32 v22, v22, v23
  v_cmp_eq_u32 vcc, 27, v22
  s_nop 1
  v_cndmask_b32 v20, v20, v27, vcc
  v_lshrrev_b32 v22, 6, v21
  v_mul_u32_u24 v23, 2341, v22
  v_lshrrev_b32 v23, 16, v23
  v_mul_u32_u24 v23, 28, v23
  v_sub_u32 v22, v22, v23
  v_cmp_eq_u32 vcc, 27, v22
  s_nop 1
  v_cndmask_b32 v21, v21, v27, vcc
  v_cmp_le_u32 vcc, 14336, v21
  s_nop 1
  v_cndmask_b32 v21, v21, v27, vcc
  s_mov_b64 s[8:9], -1
  s_mul_i32 s3, s74, 448
  s_add_u32 s3, s3, 16076800
  v_and_b32 v22, 3, v155
  v_lshrrev_b32 v23, 4, v155
  v_lshl_add_u32 v22, v22, 2, v23
  v_lshlrev_b32 v22, 5, v22
  s_lshl_b32 s4, s26, 2
  v_add_u32 v22, s4, v22
sequential_preLN__mha_block__moe_arch_mod__prompt_kernel_poll124:
  buffer_load_dwordx4 v[60:63], v20, s[20:23], s3 offen sc1
  buffer_load_dwordx4 v[64:67], v21, s[20:23], s3 offen sc1
  s_waitcnt vmcnt(0)
  v_max3_u32 v23, v60, v61, v62
  v_max3_u32 v27, v63, v64, v65
  v_max3_u32 v23, v23, v66, v67
  v_max_u32 v23, v23, v27
  v_cmp_eq_u32 vcc, -1, v23
  s_nop 4
  s_cbranch_vccz sequential_preLN__mha_block__moe_arch_mod__prompt_kernel_ok125
  s_sub_u32 s75, s75, 1
  s_cbranch_scc1 sequential_preLN__mha_block__moe_arch_mod__prompt_kernel_end1
  s_branch sequential_preLN__mha_block__moe_arch_mod__prompt_kernel_poll124
sequential_preLN__mha_block__moe_arch_mod__prompt_kernel_ok125:
  s_mov_b64 exec, s[8:9]
  v_add_f32 v60, v60, v64
  v_add_f32 v61, v61, v65
  v_add_f32 v62, v62, v66
  v_add_f32 v63, v63, v67
  s_mov_b64 exec, -1
  v_permlane32_swap_b32 v60, v62
  v_permlane32_swap_b32 v61, v63
  v_add_f32 v60, v60, v62
  v_add_f32 v61, v61, v63
  s_nop 1
  v_permlane16_swap_b32 v60, v61
  v_add_f32 v60, v60, v61
  s_nop 1
  v_add_f32_dpp v60, v60, v60 row_ror:4 row_mask:0xf bank_mask:0xf
  s_nop 1
  v_add_f32_dpp v60, v60, v60 row_ror:8 row_mask:0xf bank_mask:0xf
  s_mov_b32 exec_lo, 0x000f000f
  s_mov_b32 exec_hi, 0x000f000f
  ds_write_b32 v22, v60
  s_mov_b64 exec, -1
  s_waitcnt lgkmcnt(0)
  s_barrier
  s_cmp_lg_u32 s26, 0
  s_cbranch_scc1 sequential_preLN__mha_block__moe_arch_mod__prompt_kernel_fin3126
  v_lshlrev_b32 v20, 5, v155
  s_mov_b64 exec, 0xffff
  ds_read_b128 v[60:63], v20
  ds_read_b128 v[64:67], v20 offset:16
  v_lshlrev_b32 v20, 1, v155
  s_mul_i32 s61, s61, 1280
  s_add_u32 s61, s61, s74
  s_waitcnt lgkmcnt(0)
  v_add_f32 v60, v60, v61
  v_add_f32 v62, v62, v63
  v_add_f32 v64, v64, v65
  v_add_f32 v66, v66, v67
  v_add_f32 v60, v60, v62
  v_add_f32 v64, v64, v66
  v_add_f32 v60, v60, v64
  v_cvt_pk_bf16_f32 v60, v60, v60
  v_and_b32 v60, 0xffff0000, v60
  v_mul_f32 v60, v60, v26
  v_cvt_pk_bf16_f32 v60, v60, v60
  v_and_b32 v60, 0xffff0000, v60
  v_add_f32 v60, v60, v24
  v_cvt_pk_bf16_f32 v60, v60, v60
  v_and_b32 v60, 0xffff0000, v60
  v_add_f32 v60, v60, v25
  v_cvt_pk_bf16_f32 v60, v60, v60
  buffer_store_short v60, v20, s[48:51], s61 offen
sequential_preLN__mha_block__moe_arch_mod__prompt_kernel_fin3126:
  s_endpgm
sequential_preLN__mha_block__moe_arch_mod__prompt_kernel_slow92:
  v_mov_b32 v167, 0xff800000
  s_mov_b32 s4, 32
  s_mov_b32 s5, s30
sequential_preLN__mha_block__moe_arch_mod__prompt_kernel_p1127:
  buffer_load_dwordx4 v[96:99], v146, s[20:23], s5 offen sc1
  buffer_load_dwordx4 v[100:103], v146, s[20:23], s5 offen offset:2560 sc1
  buffer_load_dwordx2 v[104:105], v149, s[20:23], s5 offen sc1
  s_waitcnt vmcnt(0)
  v_mfma_f32_32x32x16_bf16 v[0:15], v[96:99], v[140:143], 0
  v_mfma_f32_32x32x16_bf16 v[16:31], v[100:103], v[140:143], 0
  s_nop 9
  v_mfma_f32_32x32x4_2b_bf16 v[0:31], v[104:105], v[144:145], v[0:31]
  s_add_u32 s5, s5, 5120
  s_nop 15
  s_nop 2
  v_max3_f32 v167, v167, v0, v1
  v_max3_f32 v167, v167, v2, v3
  v_max3_f32 v167, v167, v4, v5
  v_max3_f32 v167, v167, v6, v7
  v_max3_f32 v167, v167, v8, v9
  v_max3_f32 v167, v167, v10, v11
  v_max3_f32 v167, v167, v12, v13
  v_max3_f32 v167, v167, v14, v15
  v_max3_f32 v167, v167, v16, v17
  v_max3_f32 v167, v167, v18, v19
  v_max3_f32 v167, v167, v20, v21
  v_max3_f32 v167, v167, v22, v23
  v_max3_f32 v167, v167, v24, v25
  v_max3_f32 v167, v167, v26, v27
  v_max3_f32 v167, v167, v28, v29
  v_max3_f32 v167, v167, v30, v31
  s_sub_u32 s4, s4, 1
  s_cmp_lg_u32 s4, 0
  s_cbranch_scc1 sequential_preLN__mha_block__moe_arch_mod__prompt_kernel_p1127
  v_mov_b32 v164, v167
  s_nop 1
  v_permlane32_swap_b32 v164, v167
  v_max_f32 v167, v167, v164
  v_mul_f32 v32, -1.0, v167
  v_mul_f32 v33, -1.0, v167
  v_mul_f32 v34, -1.0, v167
  v_mul_f32 v35, -1.0, v167
  v_mul_f32 v36, -1.0, v167
  v_mul_f32 v37, -1.0, v167
  v_mul_f32 v38, -1.0, v167
  v_mul_f32 v39, -1.0, v167
  v_mul_f32 v40, -1.0, v167
  v_mul_f32 v41, -1.0, v167
  v_mul_f32 v42, -1.0, v167
  v_mul_f32 v43, -1.0, v167
  v_mul_f32 v44, -1.0, v167
  v_mul_f32 v45, -1.0, v167
  v_mul_f32 v46, -1.0, v167
  v_mul_f32 v47, -1.0, v167
  v_mov_b32 v80, 0
  v_mov_b32 v81, 0
  v_mov_b32 v82, 0
  v_mov_b32 v83, 0
  v_mov_b32 v84, 0
  v_mov_b32 v85, 0
  v_mov_b32 v86, 0
  v_mov_b32 v87, 0
  v_mov_b32 v88, 0
  v_mov_b32 v89, 0
  v_mov_b32 v90, 0
  v_mov_b32 v91, 0
  v_mov_b32 v92, 0
  v_mov_b32 v93, 0
  v_mov_b32 v94, 0
  v_mov_b32 v95, 0
  s_mov_b32 s4, 32
  s_mov_b32 s5, s30
sequential_preLN__mha_block__moe_arch_mod__prompt_kernel_p2128:
  buffer_load_dwordx4 v[96:99], v146, s[20:23], s5 offen sc1
  buffer_load_dwordx4 v[100:103], v146, s[20:23], s5 offen offset:2560 sc1
  buffer_load_dwordx2 v[104:105], v149, s[20:23], s5 offen sc1
  s_mov_b64 exec, s[40:41]
  buffer_load_dwordx4 v[108:111], v152, s[20:23], s5 offen offset:0 sc1
  buffer_load_dwordx4 v[112:115], v152, s[20:23], s5 offen offset:640 sc1
  buffer_load_dwordx4 v[116:119], v152, s[20:23], s5 offen offset:2560 sc1
  buffer_load_dwordx4 v[120:123], v152, s[20:23], s5 offen offset:3200 sc1
  s_mov_b64 exec, -1
  s_waitcnt vmcnt(0)
  v_mfma_f32_32x32x16_bf16 v[0:15], v[96:99], v[140:143], v[32:47]
  v_mfma_f32_32x32x16_bf16 v[16:31], v[100:103], v[140:143], v[32:47]
  s_nop 9
  v_mfma_f32_32x32x4_2b_bf16 v[0:31], v[104:105], v[144:145], v[0:31]
  s_add_u32 s5, s5, 5120
  s_nop 15
  s_nop 2
  v_exp_f32 v0, v0
  v_exp_f32 v1, v1
  v_exp_f32 v2, v2
  v_exp_f32 v3, v3
  v_exp_f32 v4, v4
  v_exp_f32 v5, v5
  v_exp_f32 v6, v6
  v_exp_f32 v7, v7
  v_exp_f32 v8, v8
  v_exp_f32 v9, v9
  v_exp_f32 v10, v10
  v_exp_f32 v11, v11
  v_exp_f32 v12, v12
  v_exp_f32 v13, v13
  v_exp_f32 v14, v14
  v_exp_f32 v15, v15
  v_exp_f32 v16, v16
  v_exp_f32 v17, v17
  v_exp_f32 v18, v18
  v_exp_f32 v19, v19
  v_exp_f32 v20, v20
  v_exp_f32 v21, v21
  v_exp_f32 v22, v22
  v_exp_f32 v23, v23
  v_exp_f32 v24, v24
  v_exp_f32 v25, v25
  v_exp_f32 v26, v26
  v_exp_f32 v27, v27
  v_exp_f32 v28, v28
  v_exp_f32 v29, v29
  v_exp_f32 v30, v30
  v_exp_f32 v31, v31
  v_cvt_pk_bf16_f32 v64, v0, v1
  v_cvt_pk_bf16_f32 v65, v2, v3
  v_cvt_pk_bf16_f32 v66, v4, v5
  v_cvt_pk_bf16_f32 v67, v6, v7
  v_cvt_pk_bf16_f32 v68, v8, v9
  v_cvt_pk_bf16_f32 v69, v10, v11
  v_cvt_pk_bf16_f32 v70, v12, v13
  v_cvt_pk_bf16_f32 v71, v14, v15
  v_cvt_pk_bf16_f32 v72, v16, v17
  v_cvt_pk_bf16_f32 v73, v18, v19
  v_cvt_pk_bf16_f32 v74, v20, v21
  v_cvt_pk_bf16_f32 v75, v22, v23
  v_cvt_pk_bf16_f32 v76, v24, v25
  v_cvt_pk_bf16_f32 v77, v26, v27
  v_cvt_pk_bf16_f32 v78, v28, v29
  v_cvt_pk_bf16_f32 v79, v30, v31
  v_mfma_f32_32x32x16_bf16 v[80:95], v[108:111], v[64:67], v[80:95]
  v_mfma_f32_32x32x16_bf16 v[80:95], v[112:115], v[68:71], v[80:95]
  v_mfma_f32_32x32x16_bf16 v[80:95], v[116:119], v[72:75], v[80:95]
  v_mfma_f32_32x32x16_bf16 v[80:95], v[120:123], v[76:79], v[80:95]
  s_sub_u32 s4, s4, 1
  s_cmp_lg_u32 s4, 0
  s_cbranch_scc1 sequential_preLN__mha_block__moe_arch_mod__prompt_kernel_p2128
  s_nop 15
  s_branch sequential_preLN__mha_block__moe_arch_mod__prompt_kernel_finA91
sequential_preLN__mha_block__moe_arch_mod__prompt_kernel_end1:
  s_endpgm
.section .rodata,"a"
.p2align 6
.amdhsa_kernel sequential_preLN__mha_block__moe_arch_mod__prompt_kernel
  .amdhsa_next_free_vgpr 256
  .amdhsa_next_free_sgpr 102
  .amdhsa_accum_offset 256
  .amdhsa_group_segment_fixed_size 0
  .amdhsa_kernarg_size 88
  .amdhsa_user_sgpr_count 2
  .amdhsa_user_sgpr_kernarg_segment_ptr 1
  .amdhsa_system_sgpr_workgroup_id_x 1
.end_amdhsa_kernel
```
